```python
import torch

def _softmax(x, axis=-1):
    return torch.softmax(x, dim=axis)
def _gelu(x):
    return torch.nn.functional.gelu(x, approximate="tanh")
def _silu(x):
    return torch.nn.functional.silu(x)
def _sigmoid(x):
    return torch.sigmoid(x)
def _layernorm(x, axis=-1, eps=1e-5):
    m = x.mean(dim=axis, keepdim=True)
    v = x.var(dim=axis, keepdim=True, unbiased=False)
    return (x - m) / torch.sqrt(v + eps)
def _scatter_add(tgt, idx, src, axis=0):
    return tgt.clone().index_add_(axis, idx, src)
def _segment_sum(src, seg, n):
    out = torch.zeros((n,) + src.shape[1:], dtype=src.dtype)
    return out.index_add_(0, seg, src)
def _pad(x, pw):
    flat = tuple(v for pair in reversed(pw) for v in pair)
    return torch.nn.functional.pad(x, flat)

kernel_name = 'recurrent_scan__mha_block_cached__swiglu_ffn__decode'

def setup_inputs():

    _w = (lambda a: (lambda t: t.to(torch.bfloat16) if t.is_floating_point() else t)(torch.as_tensor(a)))
    def _A_setup():
        B, Sq, D = 2, 1, 512
        H, Sk, Dh = 32, 16384, 128
        return {
            "x": _w((lambda *s: torch.randn(*s, dtype=torch.bfloat16) * 0.05)(B, Sq, D)),
            "k_cache": _w((lambda *s: torch.randn(*s, dtype=torch.bfloat16) * 1.6)(B, H, Sk, Dh)),
            "v_cache": _w((lambda *s: torch.randn(*s, dtype=torch.bfloat16) * 0.2)(B, H, Sk, Dh)),
            "wq": _w((lambda *s: torch.randn(*s, dtype=torch.bfloat16) * 1.6)(D, H * Dh) * (D ** -0.5)),
            "wo": _w((lambda *s: torch.randn(*s, dtype=torch.bfloat16) * 0.2)(H * Dh, D) * ((H * Dh) ** -0.5)),
        }
    _A_in = _A_setup()

    def _B_setup():
        B, S, D, F = 2, 1, 512, 1792
        return {
            "x": _w((lambda *s: torch.randn(*s, dtype=torch.bfloat16) * 0.05)(B, S, D)),
            "w_gate": _w((lambda *s: torch.randn(*s, dtype=torch.bfloat16) * 0.1)(D, F)),
            "w_up": _w((lambda *s: torch.randn(*s, dtype=torch.bfloat16) * 0.1)(D, F)),
            "w_down": _w((lambda *s: torch.randn(*s, dtype=torch.bfloat16) * 0.1)(F, D)),
        }
    _B_in = _B_setup()

    return {
        "A_x": _A_in["x"],
        "A_k_cache": _A_in["k_cache"],
        "A_v_cache": _A_in["v_cache"],
        "A_wq": _A_in["wq"],
        "A_wo": _A_in["wo"],
        "B_x": _B_in["x"],
        "B_w_gate": _B_in["w_gate"],
        "B_w_up": _B_in["w_up"],
        "B_w_down": _B_in["w_down"],
    }

def reference(A_x, A_k_cache, A_v_cache, A_wq, A_wo, B_x, B_w_gate, B_w_up, B_w_down):
    def _A_ref(x, k_cache, v_cache, wq, wo):
        B, Sq, D = x.shape
        H, Dh = 32, 128
        q = (lambda x, *d: x.permute(*d))((x @ wq).reshape(B, Sq, H, Dh), 0, 2, 1, 3)
        scores = torch.einsum("bhqd,bhkd->bhqk", q, k_cache) * (Dh ** -0.5)
        p = _softmax(scores, axis=-1)
        o = torch.einsum("bhqk,bhkd->bhqd", p, v_cache)
        return (lambda x, *d: x.permute(*d))(o, 0, 2, 1, 3).reshape(B, Sq, H * Dh) @ wo

    def _B_ref(x, w_gate, w_up, w_down):
        g = _silu(x @ w_gate)
        u = x @ w_up
        return (g * u) @ w_down

    x = A_x
    xn = _layernorm(x, axis=-1)
    s = _A_ref(xn, A_k_cache, A_v_cache, A_wq, A_wo)
    g = _silu(_B_ref(xn, B_w_gate, B_w_up, B_w_down))
    return x + s * g
```

```asm
; @launch grid=(256,1,1) block=(256,1,1) lds=89344
.amdgcn_target "amdgcn-amd-amdhsa--gfx950"
.text
.globl recurrent_scan__mha_block_cached__swiglu_ffn__decode_kernel
.p2align 8
.type recurrent_scan__mha_block_cached__swiglu_ffn__decode_kernel,@function
recurrent_scan__mha_block_cached__swiglu_ffn__decode_kernel:
  s_cmp_ge_u32 s2, 256
  s_cbranch_scc1 L_end
  s_load_dwordx16 s[4:19], s[0:1], 0
  s_load_dwordx8 s[20:27], s[0:1], 64
  v_lshrrev_b32 v9, 6, v0
  v_lshlrev_b32 v6, 8, v0
  v_and_b32 v0, 63, v0
  v_readfirstlane_b32 s52, v9
  v_lshrrev_b32 v1, 4, v0
  v_and_b32 v2, 15, v0
  s_and_b32 s53, s2, 7
  s_lshr_b32 s54, s2, 3
  s_and_b32 s55, s2, 31
  s_lshr_b32 s56, s2, 5
  v_lshlrev_b32 v42, 5, v0
  v_lshrrev_b32 v9, 5, v0
  v_and_b32 v10, 31, v0
  v_lshlrev_b32 v10, 3, v10
  v_lshl_add_u32 v43, v9, 10, v10
  s_lshl_b32 s72, s52, 8
  v_add_u32 v43, s72, v43
  v_lshlrev_b32 v48, 4, v2
  v_lshl_add_u32 v62, v1, 18, v48
  s_lshl_b32 s72, s52, 20
  s_lshl_b32 s73, s55, 8
  s_add_u32 s72, s72, s73
  v_add_u32 v62, s72, v62
  v_lshlrev_b32 v3, 4, v0
  s_bfe_u32 s64, s56, 65536
  s_lshl_b32 s64, s64, 16
  s_bfe_u32 s72, s56, 65537
  s_lshl_b32 s72, s72, 17
  s_or_b32 s64, s64, s72
  s_bfe_u32 s72, s56, 65538
  s_lshl_b32 s72, s72, 21
  s_or_b32 s64, s64, s72
  s_lshl_b32 s59, s52, 10
  s_add_u32 s64, s64, s59
  s_lshl_b32 s72, s55, 22
  s_add_u32 s64, s64, s72
  s_mov_b32 s32, s64
  s_add_u32 s64, s64, 134217728
  s_and_b32 s61, s56, 3
  s_lshl_b32 s61, s61, 16
  s_mov_b32 s38, 4194304
  s_mov_b32 s39, 0x20000
  s_mov_b32 s30, 268435456
  s_mov_b32 s31, 0x20000
  s_waitcnt lgkmcnt(0)
  global_load_dwordx4 v[32:35], v42, s[4:5]
  global_load_dwordx4 v[36:39], v42, s[4:5] offset:16
  global_load_dwordx2 v[40:41], v43, s[4:5]
  s_mov_b32 s28, s6
  s_mov_b32 s29, s7
  s_mov_b32 s36, s10
  s_mov_b32 s37, s11
  s_add_u32 s65, s32, 1572864
  buffer_load_dwordx4 a[64:67], v3, s[28:31], s65 offen nt
  s_add_u32 s65, s32, 1576960
  buffer_load_dwordx4 a[68:71], v3, s[28:31], s65 offen nt
  s_add_u32 s72, s61, 0
  s_and_b32 s72, s72, 0x3ffff
  buffer_load_dwordx4 a[0:3], v62, s[36:39], s72 offen
  s_add_u32 s65, s32, 1581056
  buffer_load_dwordx4 a[72:75], v3, s[28:31], s65 offen nt
  s_add_u32 s65, s32, 1585152
  buffer_load_dwordx4 a[76:79], v3, s[28:31], s65 offen nt
  s_add_u32 s72, s61, 8192
  s_and_b32 s72, s72, 0x3ffff
  buffer_load_dwordx4 a[4:7], v62, s[36:39], s72 offen
  s_add_u32 s65, s32, 1589248
  buffer_load_dwordx4 a[80:83], v3, s[28:31], s65 offen nt
  s_add_u32 s65, s32, 1593344
  buffer_load_dwordx4 a[84:87], v3, s[28:31], s65 offen nt
  s_add_u32 s72, s61, 16384
  s_and_b32 s72, s72, 0x3ffff
  buffer_load_dwordx4 a[8:11], v62, s[36:39], s72 offen
  s_add_u32 s65, s32, 1597440
  buffer_load_dwordx4 a[88:91], v3, s[28:31], s65 offen nt
  s_add_u32 s65, s32, 1601536
  buffer_load_dwordx4 a[92:95], v3, s[28:31], s65 offen nt
  s_add_u32 s72, s61, 24576
  s_and_b32 s72, s72, 0x3ffff
  buffer_load_dwordx4 a[12:15], v62, s[36:39], s72 offen
  s_add_u32 s65, s32, 1605632
  buffer_load_dwordx4 a[96:99], v3, s[28:31], s65 offen nt
  s_add_u32 s65, s32, 1609728
  buffer_load_dwordx4 a[100:103], v3, s[28:31], s65 offen nt
  s_add_u32 s72, s61, 32768
  s_and_b32 s72, s72, 0x3ffff
  buffer_load_dwordx4 a[16:19], v62, s[36:39], s72 offen
  s_add_u32 s65, s32, 1613824
  buffer_load_dwordx4 a[104:107], v3, s[28:31], s65 offen nt
  s_mov_b32 s40, s26
  s_mov_b32 s41, s27
  s_mov_b32 s42, 8388608
  s_mov_b32 s43, 0x20000
  s_mov_b32 s44, s24
  s_mov_b32 s45, s25
  s_mov_b32 s46, 256
  s_mov_b32 s47, 0x20000
  s_mov_b32 s48, s22
  s_mov_b32 s49, s23
  s_mov_b32 s50, 2048
  s_mov_b32 s51, 0x20000
  s_mov_b32 s68, 0xcccccccc
  s_mov_b32 s69, 0xcccccccc
  s_mov_b32 s70, 0xaaaaaaaa
  s_mov_b32 s71, 0xaaaaaaaa
  s_mov_b32 s79, 0x3f803f80
  s_mov_b32 s83, 0x80000
  s_movk_i32 s81, 4096
  s_mov_b32 s60, 0
  s_and_b32 s72, s54, 7
  s_cmp_eq_u32 s72, s53
  s_cselect_b32 s77, 1, 0
  s_mov_b32 s76, 99
  s_mov_b32 s82, 0
  s_add_u32 s82, s82, 1
  s_add_u32 s57, s54, 32
  s_lshl_b32 s57, s57, 22
  s_lshl_b32 s72, s52, 10
  s_add_u32 s57, s57, s59
  s_lshl_b32 s33, s54, 15
  s_add_u32 s33, s33, s72
  s_add_u32 s33, s33, 4194304
  s_bfe_u32 s62, s53, 65536
  s_lshl_b32 s62, s62, 16
  s_bfe_u32 s72, s53, 65537
  s_lshl_b32 s72, s72, 17
  s_or_b32 s62, s62, s72
  s_bfe_u32 s72, s53, 65538
  s_lshl_b32 s72, s72, 21
  s_or_b32 s62, s62, s72
  s_add_u32 s62, s62, s57
  s_lshl_b32 s66, s54, 8
  s_add_u32 s66, s66, 524288
  s_lshl_b32 s72, s55, 3
  s_add_u32 s72, s72, s56
  s_lshl_b32 s58, s72, 10
  v_lshlrev_b32 v5, 23, v0
  v_lshlrev_b32 v55, 2, v0
  v_lshlrev_b32 v63, 1, v0
  s_lshl_b32 s72, s52, 11
  v_add_u32 v51, s72, v63
  v_add_u32 v6, s2, v6
  v_add_u32 v9, 31, v0
  v_lshrrev_b32 v9, 6, v9
  v_lshl_add_u32 v61, v9, 23, v3
  v_and_b32 v9, 1, v1
  v_lshlrev_b32 v9, 4, v9
  v_lshl_add_u32 v49, v2, 5, v9
  v_lshl_add_u32 v60, v1, 12, v48
  s_lshr_b32 s72, s2, 2
  s_lshl_b32 s72, s72, 16
  s_lshl_b32 s73, s52, 14
  s_add_u32 s72, s72, s73
  s_and_b32 s73, s2, 3
  s_lshl_b32 s73, s73, 8
  s_add_u32 s72, s72, s73
  v_add_u32 v60, s72, v60
  v_lshrrev_b32 v9, 1, v1
  v_lshlrev_b32 v9, 4, v9
  v_lshrrev_b32 v10, 2, v2
  v_add_u32 v9, v9, v10
  v_and_b32 v10, 0x7f, v49
  v_lshl_add_u32 v4, v9, 13, v10
  s_and_b32 s72, s2, 3
  s_lshl_b32 s72, s72, 15
  s_lshr_b32 s73, s2, 2
  s_lshl_b32 s73, s73, 7
  s_add_u32 s72, s72, s73
  s_add_u32 s72, s72, 1048576
  v_add_u32 v4, s72, v4
  s_lshl_b32 s72, s52, 2
  v_add_u32 v9, s72, v9
  v_lshl_add_u32 v54, v9, 13, v10
  v_add_u32 v54, 2097152, v54
  v_and_b32 v53, 7, v0
  v_lshl_add_u32 v53, v53, 2, v1
  s_lshl_b32 s72, s54, 6
  v_lshl_add_u32 v53, v53, 1, s72
  v_and_b32 v9, 1, v2
  v_lshlrev_b32 v9, 4, v9
  v_mov_b32 v10, 0xffff
  v_lshlrev_b32 v9, v9, v10
  v_bfe_u32 v10, v2, 1, 2
  v_cmp_eq_u32 vcc, 0, v10
  s_nop 1
  v_cndmask_b32 v16, 0, v9, vcc
  v_cmp_eq_u32 vcc, 1, v10
  s_nop 1
  v_cndmask_b32 v17, 0, v9, vcc
  v_cmp_eq_u32 vcc, 2, v10
  s_nop 1
  v_cndmask_b32 v18, 0, v9, vcc
  v_cmp_eq_u32 vcc, 3, v10
  s_nop 1
  v_cndmask_b32 v19, 0, v9, vcc
  v_mov_b32 v9, 0x0c0c0c0c
  s_mov_b32 s72, 0x01000100
  s_mov_b32 s73, 0x03020302
  v_bfi_b32 v12, v16, s72, v9
  v_bfi_b32 v56, v16, s73, v9
  v_bfi_b32 v13, v17, s72, v9
  v_bfi_b32 v57, v17, s73, v9
  v_bfi_b32 v14, v18, s72, v9
  v_bfi_b32 v58, v18, s73, v9
  v_bfi_b32 v15, v19, s72, v9
  v_bfi_b32 v59, v19, s73, v9
  v_lshrrev_b32 v7, 3, v2
  v_lshlrev_b32 v7, 10, v7
  v_lshl_add_u32 v7, v1, 6, v7
  s_lshl_b32 s72, s52, 8
  v_add_u32 v7, s72, v7
  v_mov_b32 v10, -1
  ds_write_b32 v55, v10 offset:15104
  ds_write_b32 v55, v10 offset:15360
  s_mov_b32 s34, 0
  v_mov_b32 v28, -1
  v_mov_b32 v29, -1
  v_mov_b32 v30, -1
  v_mov_b32 v31, -1
  s_cmp_eq_u32 s77, 0
  s_cbranch_scc1 L_h1a
  s_lshl_b32 s72, s54, 13
  s_lshl_b32 s73, s52, 11
  s_add_u32 s72, s72, s73
  s_add_u32 s72, s72, 2097152
  buffer_store_dwordx4 v[28:31], v3, s[40:43], s72 offen sc1
  buffer_store_dwordx4 v[28:31], v3, s[40:43], s72 offen offset:1024 sc1
L_h1a:
  s_cmp_lg_u32 s52, 0
  s_cbranch_scc1 L_h1b
  buffer_store_dwordx4 v[28:31], v4, s[40:43], 0 offen sc1
  buffer_store_dwordx4 v[28:31], v61, s[40:43], s58 offen sc1
  s_add_u32 s72, s2, 256
  s_lshl_b32 s72, s72, 10
  buffer_store_dwordx4 v[28:31], v61, s[40:43], s72 offen sc1
  s_cmp_lg_u32 s53, 0
  s_cbranch_scc1 L_h1b
  v_mov_b32 v9, 0
  buffer_store_dword v9, v5, s[40:43], s66 offen sc1
L_h1b:
  s_waitcnt vmcnt(16)
  v_dot2_f32_bf16 v20, v32, s79, 0
  v_dot2_f32_bf16 v20, v33, s79, v20
  v_dot2_f32_bf16 v20, v34, s79, v20
  v_dot2_f32_bf16 v20, v35, s79, v20
  v_dot2_f32_bf16 v20, v36, s79, v20
  v_dot2_f32_bf16 v20, v37, s79, v20
  v_dot2_f32_bf16 v20, v38, s79, v20
  v_dot2_f32_bf16 v20, v39, s79, v20
  s_nop 1
  s_nop 1
  v_add_f32_dpp v20, v20, v20 row_ror:8 row_mask:0xf bank_mask:0xf
  s_nop 1
  v_add_f32_dpp v20, v20, v20 row_ror:4 row_mask:0xf bank_mask:0xf
  s_nop 1
  v_add_f32_dpp v20, v20, v20 row_ror:2 row_mask:0xf bank_mask:0xf
  s_nop 1
  v_add_f32_dpp v20, v20, v20 row_ror:1 row_mask:0xf bank_mask:0xf
  v_mov_b32 v24, v20
  s_nop 1
  v_permlane16_swap_b32 v24, v20
  s_nop 1
  v_add_f32 v20, v20, v24
  v_mul_f32 v21, 0x3b000000, v20
  v_mov_b32 v22, 0
  v_mov_b32 v23, 0
  v_lshlrev_b32 v24, 16, v32
  v_and_b32 v25, 0xffff0000, v32
  v_sub_f32 v24, v24, v21
  v_sub_f32 v25, v25, v21
  v_fmac_f32 v22, v24, v24
  v_fmac_f32 v23, v25, v25
  v_lshlrev_b32 v24, 16, v33
  v_and_b32 v25, 0xffff0000, v33
  v_sub_f32 v24, v24, v21
  v_sub_f32 v25, v25, v21
  v_fmac_f32 v22, v24, v24
  v_fmac_f32 v23, v25, v25
  v_lshlrev_b32 v24, 16, v34
  v_and_b32 v25, 0xffff0000, v34
  v_sub_f32 v24, v24, v21
  v_sub_f32 v25, v25, v21
  v_fmac_f32 v22, v24, v24
  v_fmac_f32 v23, v25, v25
  v_lshlrev_b32 v24, 16, v35
  v_and_b32 v25, 0xffff0000, v35
  v_sub_f32 v24, v24, v21
  v_sub_f32 v25, v25, v21
  v_fmac_f32 v22, v24, v24
  v_fmac_f32 v23, v25, v25
  v_lshlrev_b32 v24, 16, v36
  v_and_b32 v25, 0xffff0000, v36
  v_sub_f32 v24, v24, v21
  v_sub_f32 v25, v25, v21
  v_fmac_f32 v22, v24, v24
  v_fmac_f32 v23, v25, v25
  v_lshlrev_b32 v24, 16, v37
  v_and_b32 v25, 0xffff0000, v37
  v_sub_f32 v24, v24, v21
  v_sub_f32 v25, v25, v21
  v_fmac_f32 v22, v24, v24
  v_fmac_f32 v23, v25, v25
  v_lshlrev_b32 v24, 16, v38
  v_and_b32 v25, 0xffff0000, v38
  v_sub_f32 v24, v24, v21
  v_sub_f32 v25, v25, v21
  v_fmac_f32 v22, v24, v24
  v_fmac_f32 v23, v25, v25
  v_lshlrev_b32 v24, 16, v39
  v_and_b32 v25, 0xffff0000, v39
  v_sub_f32 v24, v24, v21
  v_sub_f32 v25, v25, v21
  v_fmac_f32 v22, v24, v24
  v_fmac_f32 v23, v25, v25
  v_add_f32 v20, v22, v23
  s_nop 1
  v_add_f32_dpp v20, v20, v20 row_ror:8 row_mask:0xf bank_mask:0xf
  s_nop 1
  v_add_f32_dpp v20, v20, v20 row_ror:4 row_mask:0xf bank_mask:0xf
  s_nop 1
  v_add_f32_dpp v20, v20, v20 row_ror:2 row_mask:0xf bank_mask:0xf
  s_nop 1
  v_add_f32_dpp v20, v20, v20 row_ror:1 row_mask:0xf bank_mask:0xf
  v_mov_b32 v24, v20
  s_nop 1
  v_permlane16_swap_b32 v24, v20
  s_nop 1
  v_add_f32 v20, v20, v24
  v_mul_f32 v20, 0x3b000000, v20
  v_cvt_pk_bf16_f32 v20, v20, v20
  v_lshlrev_b32 v20, 16, v20
  v_add_f32 v20, 0x3727c5ac, v20
  v_cvt_pk_bf16_f32 v20, v20, v20
  v_lshlrev_b32 v20, 16, v20
  v_sqrt_f32 v20, v20
  v_cvt_pk_bf16_f32 v21, v21, v21
  v_lshlrev_b32 v21, 16, v21
  v_cvt_pk_bf16_f32 v20, v20, v20
  v_lshlrev_b32 v20, 16, v20
  v_rcp_f32 v20, v20
  v_lshlrev_b32 v24, 16, v40
  v_and_b32 v25, 0xffff0000, v40
  v_sub_f32 v24, v24, v21
  v_sub_f32 v25, v25, v21
  v_cvt_pk_bf16_f32 v25, v24, v25
  v_lshlrev_b32 v24, 16, v25
  v_and_b32 v25, 0xffff0000, v25
  v_mul_f32 v24, v24, v20
  v_mul_f32 v25, v25, v20
  v_cvt_pk_bf16_f32 v40, v24, v25
  v_lshlrev_b32 v24, 16, v41
  v_and_b32 v25, 0xffff0000, v41
  v_sub_f32 v24, v24, v21
  v_sub_f32 v25, v25, v21
  v_cvt_pk_bf16_f32 v25, v24, v25
  v_lshlrev_b32 v24, 16, v25
  v_and_b32 v25, 0xffff0000, v25
  v_mul_f32 v24, v24, v20
  v_mul_f32 v25, v25, v20
  v_cvt_pk_bf16_f32 v41, v24, v25
  ds_write_b64 v43, v[40:41] offset:0
  s_waitcnt lgkmcnt(0)
  s_lshr_b32 s72, s61, 12
  s_add_u32 s72, s72, 0
  s_and_b32 s72, s72, 63
  v_add_u32 v24, s72, v7
  ds_read_b128 v[32:35], v24 offset:0
  s_lshr_b32 s72, s61, 12
  s_add_u32 s72, s72, 16
  s_and_b32 s72, s72, 63
  v_add_u32 v24, s72, v7
  ds_read_b128 v[36:39], v24 offset:0
  s_lshr_b32 s72, s61, 12
  s_add_u32 s72, s72, 32
  s_and_b32 s72, s72, 63
  v_add_u32 v24, s72, v7
  ds_read_b128 v[40:43], v24 offset:0
  s_lshr_b32 s72, s61, 12
  s_add_u32 s72, s72, 48
  s_and_b32 s72, s72, 63
  v_add_u32 v24, s72, v7
  ds_read_b128 v[44:47], v24 offset:0
  s_add_u32 s65, s32, 1617920
  buffer_load_dwordx4 a[108:111], v3, s[28:31], s65 offen nt
  s_add_u32 s72, s61, 40960
  s_and_b32 s72, s72, 0x3ffff
  buffer_load_dwordx4 a[20:23], v62, s[36:39], s72 offen
  s_add_u32 s65, s32, 1622016
  buffer_load_dwordx4 a[112:115], v3, s[28:31], s65 offen nt
  s_add_u32 s65, s32, 1626112
  buffer_load_dwordx4 a[116:119], v3, s[28:31], s65 offen nt
  s_add_u32 s72, s61, 49152
  s_and_b32 s72, s72, 0x3ffff
  buffer_load_dwordx4 a[24:27], v62, s[36:39], s72 offen
  s_waitcnt lgkmcnt(0)
  v_perm_b32 v20, v32, v32, v12
  v_perm_b32 v21, v32, v32, v13
  v_perm_b32 v22, v32, v32, v14
  v_perm_b32 v23, v32, v32, v15
  s_waitcnt vmcnt(18)
  s_nop 0
  v_mfma_f32_16x16x32_bf16 v[28:31], v[20:23], a[0:3], 0
  s_add_u32 s65, s32, 1630208
  buffer_load_dwordx4 a[120:123], v3, s[28:31], s65 offen nt
  s_add_u32 s65, s32, 1634304
  buffer_load_dwordx4 a[124:127], v3, s[28:31], s65 offen nt
  s_add_u32 s72, s61, 57344
  s_and_b32 s72, s72, 0x3ffff
  buffer_load_dwordx4 a[28:31], v62, s[36:39], s72 offen
  v_perm_b32 v24, v32, v32, v56
  v_perm_b32 v25, v32, v32, v57
  v_perm_b32 v26, v32, v32, v58
  v_perm_b32 v27, v32, v32, v59
  s_waitcnt vmcnt(18)
  s_nop 0
  v_mfma_f32_16x16x32_bf16 v[28:31], v[24:27], a[4:7], v[28:31]
  s_add_u32 s65, s32, 1835008
  buffer_load_dwordx4 a[128:131], v3, s[28:31], s65 offen nt
  s_add_u32 s65, s32, 1839104
  buffer_load_dwordx4 a[132:135], v3, s[28:31], s65 offen nt
  s_add_u32 s72, s61, 65536
  s_and_b32 s72, s72, 0x3ffff
  buffer_load_dwordx4 a[32:35], v62, s[36:39], s72 offen
  v_perm_b32 v20, v33, v33, v12
  v_perm_b32 v21, v33, v33, v13
  v_perm_b32 v22, v33, v33, v14
  v_perm_b32 v23, v33, v33, v15
  s_waitcnt vmcnt(18)
  s_nop 0
  v_mfma_f32_16x16x32_bf16 v[28:31], v[20:23], a[8:11], v[28:31]
  s_add_u32 s65, s32, 1843200
  buffer_load_dwordx4 a[136:139], v3, s[28:31], s65 offen nt
  s_add_u32 s65, s32, 1847296
  buffer_load_dwordx4 a[140:143], v3, s[28:31], s65 offen nt
  s_add_u32 s72, s61, 73728
  s_and_b32 s72, s72, 0x3ffff
  buffer_load_dwordx4 a[36:39], v62, s[36:39], s72 offen
  v_perm_b32 v24, v33, v33, v56
  v_perm_b32 v25, v33, v33, v57
  v_perm_b32 v26, v33, v33, v58
  v_perm_b32 v27, v33, v33, v59
  s_waitcnt vmcnt(18)
  s_nop 0
  v_mfma_f32_16x16x32_bf16 v[28:31], v[24:27], a[12:15], v[28:31]
  s_add_u32 s65, s32, 1851392
  buffer_load_dwordx4 a[144:147], v3, s[28:31], s65 offen nt
  s_add_u32 s65, s32, 1855488
  buffer_load_dwordx4 a[148:151], v3, s[28:31], s65 offen nt
  s_add_u32 s72, s61, 81920
  s_and_b32 s72, s72, 0x3ffff
  buffer_load_dwordx4 a[40:43], v62, s[36:39], s72 offen
  v_perm_b32 v20, v34, v34, v12
  v_perm_b32 v21, v34, v34, v13
  v_perm_b32 v22, v34, v34, v14
  v_perm_b32 v23, v34, v34, v15
  s_waitcnt vmcnt(18)
  s_nop 0
  v_mfma_f32_16x16x32_bf16 v[28:31], v[20:23], a[16:19], v[28:31]
  s_add_u32 s65, s32, 1859584
  buffer_load_dwordx4 a[152:155], v3, s[28:31], s65 offen nt
  s_add_u32 s65, s32, 1863680
  buffer_load_dwordx4 a[156:159], v3, s[28:31], s65 offen nt
  s_add_u32 s72, s61, 90112
  s_and_b32 s72, s72, 0x3ffff
  buffer_load_dwordx4 a[44:47], v62, s[36:39], s72 offen
  v_perm_b32 v24, v34, v34, v56
  v_perm_b32 v25, v34, v34, v57
  v_perm_b32 v26, v34, v34, v58
  v_perm_b32 v27, v34, v34, v59
  s_waitcnt vmcnt(18)
  s_nop 0
  v_mfma_f32_16x16x32_bf16 v[28:31], v[24:27], a[20:23], v[28:31]
  s_add_u32 s65, s32, 1867776
  buffer_load_dwordx4 a[160:163], v3, s[28:31], s65 offen nt
  s_add_u32 s65, s32, 1871872
  buffer_load_dwordx4 a[164:167], v3, s[28:31], s65 offen nt
  s_add_u32 s72, s61, 98304
  s_and_b32 s72, s72, 0x3ffff
  buffer_load_dwordx4 a[48:51], v62, s[36:39], s72 offen
  v_perm_b32 v20, v35, v35, v12
  v_perm_b32 v21, v35, v35, v13
  v_perm_b32 v22, v35, v35, v14
  v_perm_b32 v23, v35, v35, v15
  s_waitcnt vmcnt(18)
  s_nop 0
  v_mfma_f32_16x16x32_bf16 v[28:31], v[20:23], a[24:27], v[28:31]
  s_add_u32 s65, s32, 1875968
  buffer_load_dwordx4 a[168:171], v3, s[28:31], s65 offen nt
  s_add_u32 s65, s32, 1880064
  buffer_load_dwordx4 a[172:175], v3, s[28:31], s65 offen nt
  s_add_u32 s72, s61, 106496
  s_and_b32 s72, s72, 0x3ffff
  buffer_load_dwordx4 a[52:55], v62, s[36:39], s72 offen
  v_perm_b32 v24, v35, v35, v56
  v_perm_b32 v25, v35, v35, v57
  v_perm_b32 v26, v35, v35, v58
  v_perm_b32 v27, v35, v35, v59
  s_waitcnt vmcnt(18)
  s_nop 0
  v_mfma_f32_16x16x32_bf16 v[28:31], v[24:27], a[28:31], v[28:31]
  s_add_u32 s65, s32, 1884160
  buffer_load_dwordx4 a[176:179], v3, s[28:31], s65 offen nt
  s_add_u32 s65, s32, 1888256
  buffer_load_dwordx4 a[180:183], v3, s[28:31], s65 offen nt
  s_add_u32 s72, s61, 114688
  s_and_b32 s72, s72, 0x3ffff
  buffer_load_dwordx4 a[56:59], v62, s[36:39], s72 offen
  v_perm_b32 v20, v36, v36, v12
  v_perm_b32 v21, v36, v36, v13
  v_perm_b32 v22, v36, v36, v14
  v_perm_b32 v23, v36, v36, v15
  s_waitcnt vmcnt(18)
  s_nop 0
  v_mfma_f32_16x16x32_bf16 v[28:31], v[20:23], a[32:35], v[28:31]
  s_add_u32 s65, s32, 1892352
  buffer_load_dwordx4 a[184:187], v3, s[28:31], s65 offen nt
  s_add_u32 s65, s32, 1896448
  buffer_load_dwordx4 a[188:191], v3, s[28:31], s65 offen nt
  s_add_u32 s72, s61, 122880
  s_and_b32 s72, s72, 0x3ffff
  buffer_load_dwordx4 a[60:63], v62, s[36:39], s72 offen
  v_perm_b32 v24, v36, v36, v56
  v_perm_b32 v25, v36, v36, v57
  v_perm_b32 v26, v36, v36, v58
  v_perm_b32 v27, v36, v36, v59
  s_waitcnt vmcnt(18)
  s_nop 0
  v_mfma_f32_16x16x32_bf16 v[28:31], v[24:27], a[36:39], v[28:31]
  s_add_u32 s65, s64, 1572864
  buffer_load_dwordx4 v[128:131], v3, s[28:31], s65 offen nt
  s_add_u32 s65, s64, 1576960
  buffer_load_dwordx4 v[132:135], v3, s[28:31], s65 offen nt
  s_add_u32 s72, s61, 131072
  s_and_b32 s72, s72, 0x3ffff
  buffer_load_dwordx4 a[0:3], v62, s[36:39], s72 offen
  v_perm_b32 v20, v37, v37, v12
  v_perm_b32 v21, v37, v37, v13
  v_perm_b32 v22, v37, v37, v14
  v_perm_b32 v23, v37, v37, v15
  s_waitcnt vmcnt(18)
  s_nop 0
  v_mfma_f32_16x16x32_bf16 v[28:31], v[20:23], a[40:43], v[28:31]
  s_add_u32 s65, s64, 1581056
  buffer_load_dwordx4 v[136:139], v3, s[28:31], s65 offen nt
  s_add_u32 s65, s64, 1585152
  buffer_load_dwordx4 v[140:143], v3, s[28:31], s65 offen nt
  s_add_u32 s72, s61, 139264
  s_and_b32 s72, s72, 0x3ffff
  buffer_load_dwordx4 a[4:7], v62, s[36:39], s72 offen
  v_perm_b32 v24, v37, v37, v56
  v_perm_b32 v25, v37, v37, v57
  v_perm_b32 v26, v37, v37, v58
  v_perm_b32 v27, v37, v37, v59
  s_waitcnt vmcnt(18)
  s_nop 0
  v_mfma_f32_16x16x32_bf16 v[28:31], v[24:27], a[44:47], v[28:31]
  s_add_u32 s65, s64, 1589248
  buffer_load_dwordx4 v[144:147], v3, s[28:31], s65 offen nt
  s_add_u32 s65, s64, 1593344
  buffer_load_dwordx4 v[148:151], v3, s[28:31], s65 offen nt
  s_add_u32 s72, s61, 147456
  s_and_b32 s72, s72, 0x3ffff
  buffer_load_dwordx4 a[8:11], v62, s[36:39], s72 offen
  v_perm_b32 v20, v38, v38, v12
  v_perm_b32 v21, v38, v38, v13
  v_perm_b32 v22, v38, v38, v14
  v_perm_b32 v23, v38, v38, v15
  s_waitcnt vmcnt(18)
  s_nop 0
  v_mfma_f32_16x16x32_bf16 v[28:31], v[20:23], a[48:51], v[28:31]
  s_add_u32 s65, s64, 1597440
  buffer_load_dwordx4 v[152:155], v3, s[28:31], s65 offen nt
  s_add_u32 s65, s64, 1601536
  buffer_load_dwordx4 v[156:159], v3, s[28:31], s65 offen nt
  s_add_u32 s72, s61, 155648
  s_and_b32 s72, s72, 0x3ffff
  buffer_load_dwordx4 a[12:15], v62, s[36:39], s72 offen
  v_perm_b32 v24, v38, v38, v56
  v_perm_b32 v25, v38, v38, v57
  v_perm_b32 v26, v38, v38, v58
  v_perm_b32 v27, v38, v38, v59
  s_waitcnt vmcnt(18)
  s_nop 0
  v_mfma_f32_16x16x32_bf16 v[28:31], v[24:27], a[52:55], v[28:31]
  s_add_u32 s65, s64, 1605632
  buffer_load_dwordx4 v[160:163], v3, s[28:31], s65 offen nt
  s_add_u32 s65, s64, 1609728
  buffer_load_dwordx4 v[164:167], v3, s[28:31], s65 offen nt
  s_add_u32 s72, s61, 163840
  s_and_b32 s72, s72, 0x3ffff
  buffer_load_dwordx4 a[16:19], v62, s[36:39], s72 offen
  v_perm_b32 v20, v39, v39, v12
  v_perm_b32 v21, v39, v39, v13
  v_perm_b32 v22, v39, v39, v14
  v_perm_b32 v23, v39, v39, v15
  s_waitcnt vmcnt(18)
  s_nop 0
  v_mfma_f32_16x16x32_bf16 v[28:31], v[20:23], a[56:59], v[28:31]
  s_add_u32 s65, s64, 1613824
  buffer_load_dwordx4 v[168:171], v3, s[28:31], s65 offen nt
  s_add_u32 s65, s64, 1617920
  buffer_load_dwordx4 v[172:175], v3, s[28:31], s65 offen nt
  s_add_u32 s72, s61, 172032
  s_and_b32 s72, s72, 0x3ffff
  buffer_load_dwordx4 a[20:23], v62, s[36:39], s72 offen
  v_perm_b32 v24, v39, v39, v56
  v_perm_b32 v25, v39, v39, v57
  v_perm_b32 v26, v39, v39, v58
  v_perm_b32 v27, v39, v39, v59
  s_waitcnt vmcnt(18)
  s_nop 0
  v_mfma_f32_16x16x32_bf16 v[28:31], v[24:27], a[60:63], v[28:31]
  s_add_u32 s65, s64, 1622016
  buffer_load_dwordx4 v[176:179], v3, s[28:31], s65 offen nt
  s_add_u32 s65, s64, 1626112
  buffer_load_dwordx4 v[180:183], v3, s[28:31], s65 offen nt
  s_add_u32 s72, s61, 180224
  s_and_b32 s72, s72, 0x3ffff
  buffer_load_dwordx4 a[24:27], v62, s[36:39], s72 offen
  v_perm_b32 v20, v40, v40, v12
  v_perm_b32 v21, v40, v40, v13
  v_perm_b32 v22, v40, v40, v14
  v_perm_b32 v23, v40, v40, v15
  s_waitcnt vmcnt(18)
  s_nop 0
  v_mfma_f32_16x16x32_bf16 v[28:31], v[20:23], a[0:3], v[28:31]
  s_add_u32 s65, s64, 1630208
  buffer_load_dwordx4 v[184:187], v3, s[28:31], s65 offen nt
  s_add_u32 s65, s64, 1634304
  buffer_load_dwordx4 v[188:191], v3, s[28:31], s65 offen nt
  s_add_u32 s72, s61, 188416
  s_and_b32 s72, s72, 0x3ffff
  buffer_load_dwordx4 a[28:31], v62, s[36:39], s72 offen
  v_perm_b32 v24, v40, v40, v56
  v_perm_b32 v25, v40, v40, v57
  v_perm_b32 v26, v40, v40, v58
  v_perm_b32 v27, v40, v40, v59
  s_waitcnt vmcnt(18)
  s_nop 0
  v_mfma_f32_16x16x32_bf16 v[28:31], v[24:27], a[4:7], v[28:31]
  s_add_u32 s65, s64, 1835008
  buffer_load_dwordx4 v[192:195], v3, s[28:31], s65 offen nt
  s_add_u32 s65, s64, 1839104
  buffer_load_dwordx4 v[196:199], v3, s[28:31], s65 offen nt
  s_add_u32 s72, s61, 196608
  s_and_b32 s72, s72, 0x3ffff
  buffer_load_dwordx4 a[32:35], v62, s[36:39], s72 offen
  v_perm_b32 v20, v41, v41, v12
  v_perm_b32 v21, v41, v41, v13
  v_perm_b32 v22, v41, v41, v14
  v_perm_b32 v23, v41, v41, v15
  s_waitcnt vmcnt(18)
  s_nop 0
  v_mfma_f32_16x16x32_bf16 v[28:31], v[20:23], a[8:11], v[28:31]
  s_add_u32 s65, s64, 1843200
  buffer_load_dwordx4 v[200:203], v3, s[28:31], s65 offen nt
  s_add_u32 s65, s64, 1847296
  buffer_load_dwordx4 v[204:207], v3, s[28:31], s65 offen nt
  s_add_u32 s72, s61, 204800
  s_and_b32 s72, s72, 0x3ffff
  buffer_load_dwordx4 a[36:39], v62, s[36:39], s72 offen
  v_perm_b32 v24, v41, v41, v56
  v_perm_b32 v25, v41, v41, v57
  v_perm_b32 v26, v41, v41, v58
  v_perm_b32 v27, v41, v41, v59
  s_waitcnt vmcnt(18)
  s_nop 0
  v_mfma_f32_16x16x32_bf16 v[28:31], v[24:27], a[12:15], v[28:31]
  s_add_u32 s65, s64, 1851392
  buffer_load_dwordx4 v[208:211], v3, s[28:31], s65 offen nt
  s_add_u32 s65, s64, 1855488
  buffer_load_dwordx4 v[212:215], v3, s[28:31], s65 offen nt
  s_add_u32 s72, s61, 212992
  s_and_b32 s72, s72, 0x3ffff
  buffer_load_dwordx4 a[40:43], v62, s[36:39], s72 offen
  v_perm_b32 v20, v42, v42, v12
  v_perm_b32 v21, v42, v42, v13
  v_perm_b32 v22, v42, v42, v14
  v_perm_b32 v23, v42, v42, v15
  s_waitcnt vmcnt(18)
  s_nop 0
  v_mfma_f32_16x16x32_bf16 v[28:31], v[20:23], a[16:19], v[28:31]
  s_add_u32 s65, s64, 1859584
  buffer_load_dwordx4 v[216:219], v3, s[28:31], s65 offen nt
  s_add_u32 s65, s64, 1863680
  buffer_load_dwordx4 v[220:223], v3, s[28:31], s65 offen nt
  s_add_u32 s72, s61, 221184
  s_and_b32 s72, s72, 0x3ffff
  buffer_load_dwordx4 a[44:47], v62, s[36:39], s72 offen
  v_perm_b32 v24, v42, v42, v56
  v_perm_b32 v25, v42, v42, v57
  v_perm_b32 v26, v42, v42, v58
  v_perm_b32 v27, v42, v42, v59
  s_waitcnt vmcnt(18)
  s_nop 0
  v_mfma_f32_16x16x32_bf16 v[28:31], v[24:27], a[20:23], v[28:31]
  s_add_u32 s65, s64, 1867776
  buffer_load_dwordx4 v[224:227], v3, s[28:31], s65 offen nt
  s_add_u32 s65, s64, 1871872
  buffer_load_dwordx4 v[228:231], v3, s[28:31], s65 offen nt
  s_add_u32 s72, s61, 229376
  s_and_b32 s72, s72, 0x3ffff
  buffer_load_dwordx4 a[48:51], v62, s[36:39], s72 offen
  v_perm_b32 v20, v43, v43, v12
  v_perm_b32 v21, v43, v43, v13
  v_perm_b32 v22, v43, v43, v14
  v_perm_b32 v23, v43, v43, v15
  s_waitcnt vmcnt(18)
  s_nop 0
  v_mfma_f32_16x16x32_bf16 v[28:31], v[20:23], a[24:27], v[28:31]
  s_add_u32 s65, s64, 1875968
  buffer_load_dwordx4 v[232:235], v3, s[28:31], s65 offen nt
  s_add_u32 s65, s64, 1880064
  buffer_load_dwordx4 v[236:239], v3, s[28:31], s65 offen nt
  s_add_u32 s72, s61, 237568
  s_and_b32 s72, s72, 0x3ffff
  buffer_load_dwordx4 a[52:55], v62, s[36:39], s72 offen
  v_perm_b32 v24, v43, v43, v56
  v_perm_b32 v25, v43, v43, v57
  v_perm_b32 v26, v43, v43, v58
  v_perm_b32 v27, v43, v43, v59
  s_waitcnt vmcnt(18)
  s_nop 0
  v_mfma_f32_16x16x32_bf16 v[28:31], v[24:27], a[28:31], v[28:31]
  s_add_u32 s65, s64, 1884160
  buffer_load_dwordx4 v[240:243], v3, s[28:31], s65 offen nt
  s_add_u32 s65, s64, 1888256
  buffer_load_dwordx4 v[244:247], v3, s[28:31], s65 offen nt
  s_add_u32 s72, s61, 245760
  s_and_b32 s72, s72, 0x3ffff
  buffer_load_dwordx4 a[56:59], v62, s[36:39], s72 offen
  v_perm_b32 v20, v44, v44, v12
  v_perm_b32 v21, v44, v44, v13
  v_perm_b32 v22, v44, v44, v14
  v_perm_b32 v23, v44, v44, v15
  s_waitcnt vmcnt(18)
  s_nop 0
  v_mfma_f32_16x16x32_bf16 v[28:31], v[20:23], a[32:35], v[28:31]
  s_add_u32 s65, s64, 1892352
  buffer_load_dwordx4 v[248:251], v3, s[28:31], s65 offen nt
  s_add_u32 s65, s64, 1896448
  buffer_load_dwordx4 v[252:255], v3, s[28:31], s65 offen nt
  s_add_u32 s72, s61, 253952
  s_and_b32 s72, s72, 0x3ffff
  buffer_load_dwordx4 a[60:63], v62, s[36:39], s72 offen
  v_perm_b32 v24, v44, v44, v56
  v_perm_b32 v25, v44, v44, v57
  v_perm_b32 v26, v44, v44, v58
  v_perm_b32 v27, v44, v44, v59
  s_waitcnt vmcnt(18)
  s_nop 0
  v_mfma_f32_16x16x32_bf16 v[28:31], v[24:27], a[36:39], v[28:31]
  buffer_load_dwordx4 v[64:67], v3, s[28:31], s64 offen nt
  s_add_u32 s65, s64, 4096
  buffer_load_dwordx4 v[68:71], v3, s[28:31], s65 offen nt
  s_add_u32 s65, s64, 8192
  buffer_load_dwordx4 v[72:75], v3, s[28:31], s65 offen nt
  v_perm_b32 v20, v45, v45, v12
  v_perm_b32 v21, v45, v45, v13
  v_perm_b32 v22, v45, v45, v14
  v_perm_b32 v23, v45, v45, v15
  s_waitcnt vmcnt(18)
  s_nop 0
  v_mfma_f32_16x16x32_bf16 v[28:31], v[20:23], a[40:43], v[28:31]
  s_add_u32 s65, s64, 12288
  buffer_load_dwordx4 v[76:79], v3, s[28:31], s65 offen nt
  s_add_u32 s65, s64, 16384
  buffer_load_dwordx4 v[80:83], v3, s[28:31], s65 offen nt
  s_add_u32 s65, s64, 20480
  buffer_load_dwordx4 v[84:87], v3, s[28:31], s65 offen nt
  v_perm_b32 v24, v45, v45, v56
  v_perm_b32 v25, v45, v45, v57
  v_perm_b32 v26, v45, v45, v58
  v_perm_b32 v27, v45, v45, v59
  s_waitcnt vmcnt(18)
  s_nop 0
  v_mfma_f32_16x16x32_bf16 v[28:31], v[24:27], a[44:47], v[28:31]
  s_add_u32 s65, s64, 24576
  buffer_load_dwordx4 v[88:91], v3, s[28:31], s65 offen nt
  s_add_u32 s65, s64, 28672
  buffer_load_dwordx4 v[92:95], v3, s[28:31], s65 offen nt
  s_add_u32 s65, s64, 32768
  buffer_load_dwordx4 v[96:99], v3, s[28:31], s65 offen nt
  v_perm_b32 v20, v46, v46, v12
  v_perm_b32 v21, v46, v46, v13
  v_perm_b32 v22, v46, v46, v14
  v_perm_b32 v23, v46, v46, v15
  s_waitcnt vmcnt(18)
  s_nop 0
  v_mfma_f32_16x16x32_bf16 v[28:31], v[20:23], a[48:51], v[28:31]
  s_add_u32 s65, s64, 36864
  buffer_load_dwordx4 v[100:103], v3, s[28:31], s65 offen nt
  s_add_u32 s65, s64, 40960
  buffer_load_dwordx4 v[104:107], v3, s[28:31], s65 offen nt
  s_add_u32 s65, s64, 45056
  buffer_load_dwordx4 v[108:111], v3, s[28:31], s65 offen nt
  v_perm_b32 v24, v46, v46, v56
  v_perm_b32 v25, v46, v46, v57
  v_perm_b32 v26, v46, v46, v58
  v_perm_b32 v27, v46, v46, v59
  s_waitcnt vmcnt(18)
  s_nop 0
  v_mfma_f32_16x16x32_bf16 v[28:31], v[24:27], a[52:55], v[28:31]
  v_perm_b32 v20, v47, v47, v12
  v_perm_b32 v21, v47, v47, v13
  v_perm_b32 v22, v47, v47, v14
  v_perm_b32 v23, v47, v47, v15
  s_waitcnt vmcnt(15)
  s_nop 0
  v_mfma_f32_16x16x32_bf16 v[28:31], v[20:23], a[56:59], v[28:31]
  v_perm_b32 v24, v47, v47, v56
  v_perm_b32 v25, v47, v47, v57
  v_perm_b32 v26, v47, v47, v58
  v_perm_b32 v27, v47, v47, v59
  s_waitcnt vmcnt(12)
  s_nop 0
  v_mfma_f32_16x16x32_bf16 v[28:31], v[24:27], a[60:63], v[28:31]
  v_lshrrev_b32 v9, 1, v1
  v_lshl_add_u32 v9, v9, 9, v49
  s_lshl_b32 s72, s52, 10
  v_add_u32 v9, s72, v9
  v_mov_b32 v7, 0xff61b1e6
  v_mov_b32 v8, 0
  s_mov_b32 s63, 0
  s_lshl_b32 s72, s52, 9
  v_add_u32 v49, s72, v49
  v_lshlrev_b32 v10, 3, v0
  ds_write_b128 v9, v[28:31] offset:4096
  s_waitcnt lgkmcnt(0)
  s_barrier
  ds_read_b64 v[32:33], v10 offset:4608
  ds_read_b64 v[34:35], v10 offset:5632
  ds_read_b64 v[36:37], v10 offset:6656
  ds_read_b64 v[38:39], v10 offset:7680
  s_waitcnt lgkmcnt(0)
  v_add_f32 v32, v32, v34
  v_add_f32 v33, v33, v35
  v_add_f32 v32, v32, v36
  v_add_f32 v33, v33, v37
  v_add_f32 v32, v32, v38
  v_add_f32 v33, v33, v39
  v_cvt_pk_bf16_f32 v32, v32, v33
  ds_bpermute_b32 v12, v48, v32 offset:0
  ds_bpermute_b32 v13, v48, v32 offset:4
  ds_bpermute_b32 v14, v48, v32 offset:8
  ds_bpermute_b32 v15, v48, v32 offset:12
  s_add_u32 s65, s64, 49152
  buffer_load_dwordx4 v[112:115], v3, s[28:31], s65 offen nt
  s_add_u32 s65, s64, 53248
  buffer_load_dwordx4 v[116:119], v3, s[28:31], s65 offen nt
  s_add_u32 s65, s64, 57344
  buffer_load_dwordx4 v[120:123], v3, s[28:31], s65 offen nt
  s_add_u32 s65, s64, 61440
  buffer_load_dwordx4 v[124:127], v3, s[28:31], s65 offen nt
  v_mov_b32 v28, 0
  v_mov_b32 v29, 0
  v_mov_b32 v30, 0
  v_mov_b32 v31, 0
  s_add_u32 s64, s64, 262144
  s_waitcnt lgkmcnt(0)
  .p2align 6
L_kloop:
  s_waitcnt vmcnt(15)
  v_dot2_f32_bf16 v32, v64, v12, 0
  v_dot2_f32_bf16 v32, v65, v13, v32
  v_dot2_f32_bf16 v32, v66, v14, v32
  v_dot2_f32_bf16 v32, v67, v15, v32
  buffer_load_dwordx4 v[64:67], v3, s[28:31], s64 offen nt
  s_waitcnt vmcnt(15)
  v_dot2_f32_bf16 v33, v68, v12, 0
  v_dot2_f32_bf16 v33, v69, v13, v33
  v_dot2_f32_bf16 v33, v70, v14, v33
  v_dot2_f32_bf16 v33, v71, v15, v33
  s_add_u32 s65, s64, 4096
  buffer_load_dwordx4 v[68:71], v3, s[28:31], s65 offen nt
  s_waitcnt vmcnt(15)
  v_dot2_f32_bf16 v34, v72, v12, 0
  v_dot2_f32_bf16 v34, v73, v13, v34
  v_dot2_f32_bf16 v34, v74, v14, v34
  v_dot2_f32_bf16 v34, v75, v15, v34
  s_add_u32 s65, s64, 8192
  buffer_load_dwordx4 v[72:75], v3, s[28:31], s65 offen nt
  s_waitcnt vmcnt(15)
  v_dot2_f32_bf16 v35, v76, v12, 0
  v_dot2_f32_bf16 v35, v77, v13, v35
  v_dot2_f32_bf16 v35, v78, v14, v35
  v_dot2_f32_bf16 v35, v79, v15, v35
  s_add_u32 s65, s64, 12288
  buffer_load_dwordx4 v[76:79], v3, s[28:31], s65 offen nt
  s_waitcnt vmcnt(15)
  v_dot2_f32_bf16 v36, v80, v12, 0
  v_dot2_f32_bf16 v36, v81, v13, v36
  v_dot2_f32_bf16 v36, v82, v14, v36
  v_dot2_f32_bf16 v36, v83, v15, v36
  s_add_u32 s65, s64, 16384
  buffer_load_dwordx4 v[80:83], v3, s[28:31], s65 offen nt
  s_waitcnt vmcnt(15)
  v_dot2_f32_bf16 v37, v84, v12, 0
  v_dot2_f32_bf16 v37, v85, v13, v37
  v_dot2_f32_bf16 v37, v86, v14, v37
  v_dot2_f32_bf16 v37, v87, v15, v37
  s_add_u32 s65, s64, 20480
  buffer_load_dwordx4 v[84:87], v3, s[28:31], s65 offen nt
  s_waitcnt vmcnt(15)
  v_dot2_f32_bf16 v38, v88, v12, 0
  v_dot2_f32_bf16 v38, v89, v13, v38
  v_dot2_f32_bf16 v38, v90, v14, v38
  v_dot2_f32_bf16 v38, v91, v15, v38
  s_add_u32 s65, s64, 24576
  buffer_load_dwordx4 v[88:91], v3, s[28:31], s65 offen nt
  s_waitcnt vmcnt(15)
  v_dot2_f32_bf16 v39, v92, v12, 0
  v_dot2_f32_bf16 v39, v93, v13, v39
  v_dot2_f32_bf16 v39, v94, v14, v39
  v_dot2_f32_bf16 v39, v95, v15, v39
  s_add_u32 s65, s64, 28672
  buffer_load_dwordx4 v[92:95], v3, s[28:31], s65 offen nt
  s_waitcnt vmcnt(15)
  v_dot2_f32_bf16 v40, v96, v12, 0
  v_dot2_f32_bf16 v40, v97, v13, v40
  v_dot2_f32_bf16 v40, v98, v14, v40
  v_dot2_f32_bf16 v40, v99, v15, v40
  s_add_u32 s65, s64, 32768
  buffer_load_dwordx4 v[96:99], v3, s[28:31], s65 offen nt
  s_waitcnt vmcnt(15)
  v_dot2_f32_bf16 v41, v100, v12, 0
  v_dot2_f32_bf16 v41, v101, v13, v41
  v_dot2_f32_bf16 v41, v102, v14, v41
  v_dot2_f32_bf16 v41, v103, v15, v41
  s_add_u32 s65, s64, 36864
  buffer_load_dwordx4 v[100:103], v3, s[28:31], s65 offen nt
  s_waitcnt vmcnt(15)
  v_dot2_f32_bf16 v42, v104, v12, 0
  v_dot2_f32_bf16 v42, v105, v13, v42
  v_dot2_f32_bf16 v42, v106, v14, v42
  v_dot2_f32_bf16 v42, v107, v15, v42
  s_add_u32 s65, s64, 40960
  buffer_load_dwordx4 v[104:107], v3, s[28:31], s65 offen nt
  s_waitcnt vmcnt(15)
  v_dot2_f32_bf16 v43, v108, v12, 0
  v_dot2_f32_bf16 v43, v109, v13, v43
  v_dot2_f32_bf16 v43, v110, v14, v43
  v_dot2_f32_bf16 v43, v111, v15, v43
  s_add_u32 s65, s64, 45056
  buffer_load_dwordx4 v[108:111], v3, s[28:31], s65 offen nt
  s_waitcnt vmcnt(15)
  v_dot2_f32_bf16 v44, v112, v12, 0
  v_dot2_f32_bf16 v44, v113, v13, v44
  v_dot2_f32_bf16 v44, v114, v14, v44
  v_dot2_f32_bf16 v44, v115, v15, v44
  s_add_u32 s65, s64, 49152
  buffer_load_dwordx4 v[112:115], v3, s[28:31], s65 offen nt
  s_waitcnt vmcnt(15)
  v_dot2_f32_bf16 v45, v116, v12, 0
  v_dot2_f32_bf16 v45, v117, v13, v45
  v_dot2_f32_bf16 v45, v118, v14, v45
  v_dot2_f32_bf16 v45, v119, v15, v45
  s_add_u32 s65, s64, 53248
  buffer_load_dwordx4 v[116:119], v3, s[28:31], s65 offen nt
  s_waitcnt vmcnt(15)
  v_dot2_f32_bf16 v46, v120, v12, 0
  v_dot2_f32_bf16 v46, v121, v13, v46
  v_dot2_f32_bf16 v46, v122, v14, v46
  v_dot2_f32_bf16 v46, v123, v15, v46
  s_add_u32 s65, s64, 57344
  buffer_load_dwordx4 v[120:123], v3, s[28:31], s65 offen nt
  s_waitcnt vmcnt(15)
  v_dot2_f32_bf16 v47, v124, v12, 0
  v_dot2_f32_bf16 v47, v125, v13, v47
  v_dot2_f32_bf16 v47, v126, v14, v47
  v_dot2_f32_bf16 v47, v127, v15, v47
  s_add_u32 s65, s64, 61440
  buffer_load_dwordx4 v[124:127], v3, s[28:31], s65 offen nt
  v_add_f32_dpp v32, v32, v32 row_ror:8 row_mask:0xf bank_mask:0x3
  v_add_f32_dpp v33, v33, v33 row_ror:8 row_mask:0xf bank_mask:0x3
  v_add_f32_dpp v34, v34, v34 row_ror:8 row_mask:0xf bank_mask:0x3
  v_add_f32_dpp v35, v35, v35 row_ror:8 row_mask:0xf bank_mask:0x3
  v_add_f32_dpp v36, v36, v36 row_ror:8 row_mask:0xf bank_mask:0x3
  v_add_f32_dpp v37, v37, v37 row_ror:8 row_mask:0xf bank_mask:0x3
  v_add_f32_dpp v38, v38, v38 row_ror:8 row_mask:0xf bank_mask:0x3
  v_add_f32_dpp v39, v39, v39 row_ror:8 row_mask:0xf bank_mask:0x3
  v_add_f32_dpp v32, v40, v40 row_ror:8 row_mask:0xf bank_mask:0xc
  v_add_f32_dpp v33, v41, v41 row_ror:8 row_mask:0xf bank_mask:0xc
  v_add_f32_dpp v34, v42, v42 row_ror:8 row_mask:0xf bank_mask:0xc
  v_add_f32_dpp v35, v43, v43 row_ror:8 row_mask:0xf bank_mask:0xc
  v_add_f32_dpp v36, v44, v44 row_ror:8 row_mask:0xf bank_mask:0xc
  v_add_f32_dpp v37, v45, v45 row_ror:8 row_mask:0xf bank_mask:0xc
  v_add_f32_dpp v38, v46, v46 row_ror:8 row_mask:0xf bank_mask:0xc
  v_add_f32_dpp v39, v47, v47 row_ror:8 row_mask:0xf bank_mask:0xc
  v_add_f32_dpp v32, v32, v32 row_shl:4 row_mask:0xf bank_mask:0x5
  v_add_f32_dpp v33, v33, v33 row_shl:4 row_mask:0xf bank_mask:0x5
  v_add_f32_dpp v34, v34, v34 row_shl:4 row_mask:0xf bank_mask:0x5
  v_add_f32_dpp v35, v35, v35 row_shl:4 row_mask:0xf bank_mask:0x5
  v_add_f32_dpp v32, v36, v36 row_shr:4 row_mask:0xf bank_mask:0xa
  v_add_f32_dpp v33, v37, v37 row_shr:4 row_mask:0xf bank_mask:0xa
  v_add_f32_dpp v34, v38, v38 row_shr:4 row_mask:0xf bank_mask:0xa
  v_add_f32_dpp v35, v39, v39 row_shr:4 row_mask:0xf bank_mask:0xa
  s_nop 0
  v_add_f32_dpp v32, v32, v32 quad_perm:[2,3,0,1] row_mask:0xf bank_mask:0xf
  v_add_f32_dpp v33, v33, v33 quad_perm:[2,3,0,1] row_mask:0xf bank_mask:0xf
  v_add_f32_dpp v34, v34, v34 quad_perm:[2,3,0,1] row_mask:0xf bank_mask:0xf
  v_add_f32_dpp v35, v35, v35 quad_perm:[2,3,0,1] row_mask:0xf bank_mask:0xf
  v_cndmask_b32 v32, v32, v34, s[68:69]
  v_cndmask_b32 v33, v33, v35, s[68:69]
  s_nop 0
  v_add_f32_dpp v32, v32, v32 quad_perm:[1,0,3,2] row_mask:0xf bank_mask:0xf
  v_add_f32_dpp v33, v33, v33 quad_perm:[1,0,3,2] row_mask:0xf bank_mask:0xf
  v_cndmask_b32 v32, v32, v33, s[70:71]
  v_cvt_pk_bf16_f32 v32, v32, v32
  v_lshlrev_b32 v32, 16, v32
  v_mul_f32 v32, 0x3db504f3, v32
  v_cvt_pk_bf16_f32 v32, v32, v32
  ds_write_b16 v51, v32 offset:15616
  v_add_u32 v51, 128, v51
  s_add_u32 s63, s63, 1
  s_add_u32 s64, s64, 262144
  s_cmp_eq_u32 s63, 1
  s_cbranch_scc1 L_h1
  s_cmp_eq_u32 s63, 7
  s_cbranch_scc1 L_h2
  s_cmp_eq_u32 s63, 5
  s_cbranch_scc1 L_hb1
  s_cmp_eq_u32 s63, 6
  s_cbranch_scc1 L_hq1
  s_cmp_eq_u32 s63, 11
  s_cbranch_scc1 L_hv
  s_cmp_eq_u32 s63, 12
  s_cbranch_scc1 L_kend
L_xd:
  s_sub_u32 s72, s63, s82
  s_cmp_gt_u32 s72, 1
  s_cbranch_scc1 L_kloop
  v_and_b32 v10, 0xfffffc7f, v51
  s_cmp_eq_u32 s72, 1
  s_cbranch_scc1 L_x1
L_x0:
  v_dot2_f32_bf16 v32, v128, v12, 0
  v_dot2_f32_bf16 v32, v129, v13, v32
  v_dot2_f32_bf16 v32, v130, v14, v32
  v_dot2_f32_bf16 v32, v131, v15, v32
  v_dot2_f32_bf16 v33, v132, v12, 0
  v_dot2_f32_bf16 v33, v133, v13, v33
  v_dot2_f32_bf16 v33, v134, v14, v33
  v_dot2_f32_bf16 v33, v135, v15, v33
  v_dot2_f32_bf16 v34, v136, v12, 0
  v_dot2_f32_bf16 v34, v137, v13, v34
  v_dot2_f32_bf16 v34, v138, v14, v34
  v_dot2_f32_bf16 v34, v139, v15, v34
  v_dot2_f32_bf16 v35, v140, v12, 0
  v_dot2_f32_bf16 v35, v141, v13, v35
  v_dot2_f32_bf16 v35, v142, v14, v35
  v_dot2_f32_bf16 v35, v143, v15, v35
  v_dot2_f32_bf16 v36, v144, v12, 0
  v_dot2_f32_bf16 v36, v145, v13, v36
  v_dot2_f32_bf16 v36, v146, v14, v36
  v_dot2_f32_bf16 v36, v147, v15, v36
  v_dot2_f32_bf16 v37, v148, v12, 0
  v_dot2_f32_bf16 v37, v149, v13, v37
  v_dot2_f32_bf16 v37, v150, v14, v37
  v_dot2_f32_bf16 v37, v151, v15, v37
  v_dot2_f32_bf16 v38, v152, v12, 0
  v_dot2_f32_bf16 v38, v153, v13, v38
  v_dot2_f32_bf16 v38, v154, v14, v38
  v_dot2_f32_bf16 v38, v155, v15, v38
  v_dot2_f32_bf16 v39, v156, v12, 0
  v_dot2_f32_bf16 v39, v157, v13, v39
  v_dot2_f32_bf16 v39, v158, v14, v39
  v_dot2_f32_bf16 v39, v159, v15, v39
  v_dot2_f32_bf16 v40, v160, v12, 0
  v_dot2_f32_bf16 v40, v161, v13, v40
  v_dot2_f32_bf16 v40, v162, v14, v40
  v_dot2_f32_bf16 v40, v163, v15, v40
  v_dot2_f32_bf16 v41, v164, v12, 0
  v_dot2_f32_bf16 v41, v165, v13, v41
  v_dot2_f32_bf16 v41, v166, v14, v41
  v_dot2_f32_bf16 v41, v167, v15, v41
  v_dot2_f32_bf16 v42, v168, v12, 0
  v_dot2_f32_bf16 v42, v169, v13, v42
  v_dot2_f32_bf16 v42, v170, v14, v42
  v_dot2_f32_bf16 v42, v171, v15, v42
  v_dot2_f32_bf16 v43, v172, v12, 0
  v_dot2_f32_bf16 v43, v173, v13, v43
  v_dot2_f32_bf16 v43, v174, v14, v43
  v_dot2_f32_bf16 v43, v175, v15, v43
  v_dot2_f32_bf16 v44, v176, v12, 0
  v_dot2_f32_bf16 v44, v177, v13, v44
  v_dot2_f32_bf16 v44, v178, v14, v44
  v_dot2_f32_bf16 v44, v179, v15, v44
  v_dot2_f32_bf16 v45, v180, v12, 0
  v_dot2_f32_bf16 v45, v181, v13, v45
  v_dot2_f32_bf16 v45, v182, v14, v45
  v_dot2_f32_bf16 v45, v183, v15, v45
  v_dot2_f32_bf16 v46, v184, v12, 0
  v_dot2_f32_bf16 v46, v185, v13, v46
  v_dot2_f32_bf16 v46, v186, v14, v46
  v_dot2_f32_bf16 v46, v187, v15, v46
  v_dot2_f32_bf16 v47, v188, v12, 0
  v_dot2_f32_bf16 v47, v189, v13, v47
  v_dot2_f32_bf16 v47, v190, v14, v47
  v_dot2_f32_bf16 v47, v191, v15, v47
  v_add_f32_dpp v32, v32, v32 row_ror:8 row_mask:0xf bank_mask:0x3
  v_add_f32_dpp v33, v33, v33 row_ror:8 row_mask:0xf bank_mask:0x3
  v_add_f32_dpp v34, v34, v34 row_ror:8 row_mask:0xf bank_mask:0x3
  v_add_f32_dpp v35, v35, v35 row_ror:8 row_mask:0xf bank_mask:0x3
  v_add_f32_dpp v36, v36, v36 row_ror:8 row_mask:0xf bank_mask:0x3
  v_add_f32_dpp v37, v37, v37 row_ror:8 row_mask:0xf bank_mask:0x3
  v_add_f32_dpp v38, v38, v38 row_ror:8 row_mask:0xf bank_mask:0x3
  v_add_f32_dpp v39, v39, v39 row_ror:8 row_mask:0xf bank_mask:0x3
  v_add_f32_dpp v32, v40, v40 row_ror:8 row_mask:0xf bank_mask:0xc
  v_add_f32_dpp v33, v41, v41 row_ror:8 row_mask:0xf bank_mask:0xc
  v_add_f32_dpp v34, v42, v42 row_ror:8 row_mask:0xf bank_mask:0xc
  v_add_f32_dpp v35, v43, v43 row_ror:8 row_mask:0xf bank_mask:0xc
  v_add_f32_dpp v36, v44, v44 row_ror:8 row_mask:0xf bank_mask:0xc
  v_add_f32_dpp v37, v45, v45 row_ror:8 row_mask:0xf bank_mask:0xc
  v_add_f32_dpp v38, v46, v46 row_ror:8 row_mask:0xf bank_mask:0xc
  v_add_f32_dpp v39, v47, v47 row_ror:8 row_mask:0xf bank_mask:0xc
  v_add_f32_dpp v32, v32, v32 row_shl:4 row_mask:0xf bank_mask:0x5
  v_add_f32_dpp v33, v33, v33 row_shl:4 row_mask:0xf bank_mask:0x5
  v_add_f32_dpp v34, v34, v34 row_shl:4 row_mask:0xf bank_mask:0x5
  v_add_f32_dpp v35, v35, v35 row_shl:4 row_mask:0xf bank_mask:0x5
  v_add_f32_dpp v32, v36, v36 row_shr:4 row_mask:0xf bank_mask:0xa
  v_add_f32_dpp v33, v37, v37 row_shr:4 row_mask:0xf bank_mask:0xa
  v_add_f32_dpp v34, v38, v38 row_shr:4 row_mask:0xf bank_mask:0xa
  v_add_f32_dpp v35, v39, v39 row_shr:4 row_mask:0xf bank_mask:0xa
  s_nop 0
  v_add_f32_dpp v32, v32, v32 quad_perm:[2,3,0,1] row_mask:0xf bank_mask:0xf
  v_add_f32_dpp v33, v33, v33 quad_perm:[2,3,0,1] row_mask:0xf bank_mask:0xf
  v_add_f32_dpp v34, v34, v34 quad_perm:[2,3,0,1] row_mask:0xf bank_mask:0xf
  v_add_f32_dpp v35, v35, v35 quad_perm:[2,3,0,1] row_mask:0xf bank_mask:0xf
  v_cndmask_b32 v32, v32, v34, s[68:69]
  v_cndmask_b32 v33, v33, v35, s[68:69]
  s_nop 0
  v_add_f32_dpp v32, v32, v32 quad_perm:[1,0,3,2] row_mask:0xf bank_mask:0xf
  v_add_f32_dpp v33, v33, v33 quad_perm:[1,0,3,2] row_mask:0xf bank_mask:0xf
  v_cndmask_b32 v32, v32, v33, s[70:71]
  v_cvt_pk_bf16_f32 v32, v32, v32
  v_lshlrev_b32 v32, 16, v32
  v_mul_f32 v32, 0x3db504f3, v32
  v_cvt_pk_bf16_f32 v32, v32, v32
  ds_write_b16 v10, v32 offset:16384
  s_cmp_gt_u32 s63, 6
  s_cbranch_scc1 L_kloop
  v_accvgpr_read_b32 v128, a64
  v_accvgpr_read_b32 v129, a65
  v_accvgpr_read_b32 v130, a66
  v_accvgpr_read_b32 v131, a67
  v_accvgpr_read_b32 v132, a68
  v_accvgpr_read_b32 v133, a69
  v_accvgpr_read_b32 v134, a70
  v_accvgpr_read_b32 v135, a71
  v_accvgpr_read_b32 v136, a72
  v_accvgpr_read_b32 v137, a73
  v_accvgpr_read_b32 v138, a74
  v_accvgpr_read_b32 v139, a75
  v_accvgpr_read_b32 v140, a76
  v_accvgpr_read_b32 v141, a77
  v_accvgpr_read_b32 v142, a78
  v_accvgpr_read_b32 v143, a79
  v_accvgpr_read_b32 v144, a80
  v_accvgpr_read_b32 v145, a81
  v_accvgpr_read_b32 v146, a82
  v_accvgpr_read_b32 v147, a83
  v_accvgpr_read_b32 v148, a84
  v_accvgpr_read_b32 v149, a85
  v_accvgpr_read_b32 v150, a86
  v_accvgpr_read_b32 v151, a87
  v_accvgpr_read_b32 v152, a88
  v_accvgpr_read_b32 v153, a89
  v_accvgpr_read_b32 v154, a90
  v_accvgpr_read_b32 v155, a91
  v_accvgpr_read_b32 v156, a92
  v_accvgpr_read_b32 v157, a93
  v_accvgpr_read_b32 v158, a94
  v_accvgpr_read_b32 v159, a95
  v_accvgpr_read_b32 v160, a96
  v_accvgpr_read_b32 v161, a97
  v_accvgpr_read_b32 v162, a98
  v_accvgpr_read_b32 v163, a99
  v_accvgpr_read_b32 v164, a100
  v_accvgpr_read_b32 v165, a101
  v_accvgpr_read_b32 v166, a102
  v_accvgpr_read_b32 v167, a103
  v_accvgpr_read_b32 v168, a104
  v_accvgpr_read_b32 v169, a105
  v_accvgpr_read_b32 v170, a106
  v_accvgpr_read_b32 v171, a107
  v_accvgpr_read_b32 v172, a108
  v_accvgpr_read_b32 v173, a109
  v_accvgpr_read_b32 v174, a110
  v_accvgpr_read_b32 v175, a111
  v_accvgpr_read_b32 v176, a112
  v_accvgpr_read_b32 v177, a113
  v_accvgpr_read_b32 v178, a114
  v_accvgpr_read_b32 v179, a115
  v_accvgpr_read_b32 v180, a116
  v_accvgpr_read_b32 v181, a117
  v_accvgpr_read_b32 v182, a118
  v_accvgpr_read_b32 v183, a119
  v_accvgpr_read_b32 v184, a120
  v_accvgpr_read_b32 v185, a121
  v_accvgpr_read_b32 v186, a122
  v_accvgpr_read_b32 v187, a123
  v_accvgpr_read_b32 v188, a124
  v_accvgpr_read_b32 v189, a125
  v_accvgpr_read_b32 v190, a126
  v_accvgpr_read_b32 v191, a127
  s_branch L_kloop
L_x1:
  v_dot2_f32_bf16 v32, v192, v12, 0
  v_dot2_f32_bf16 v32, v193, v13, v32
  v_dot2_f32_bf16 v32, v194, v14, v32
  v_dot2_f32_bf16 v32, v195, v15, v32
  v_dot2_f32_bf16 v33, v196, v12, 0
  v_dot2_f32_bf16 v33, v197, v13, v33
  v_dot2_f32_bf16 v33, v198, v14, v33
  v_dot2_f32_bf16 v33, v199, v15, v33
  v_dot2_f32_bf16 v34, v200, v12, 0
  v_dot2_f32_bf16 v34, v201, v13, v34
  v_dot2_f32_bf16 v34, v202, v14, v34
  v_dot2_f32_bf16 v34, v203, v15, v34
  v_dot2_f32_bf16 v35, v204, v12, 0
  v_dot2_f32_bf16 v35, v205, v13, v35
  v_dot2_f32_bf16 v35, v206, v14, v35
  v_dot2_f32_bf16 v35, v207, v15, v35
  v_dot2_f32_bf16 v36, v208, v12, 0
  v_dot2_f32_bf16 v36, v209, v13, v36
  v_dot2_f32_bf16 v36, v210, v14, v36
  v_dot2_f32_bf16 v36, v211, v15, v36
  v_dot2_f32_bf16 v37, v212, v12, 0
  v_dot2_f32_bf16 v37, v213, v13, v37
  v_dot2_f32_bf16 v37, v214, v14, v37
  v_dot2_f32_bf16 v37, v215, v15, v37
  v_dot2_f32_bf16 v38, v216, v12, 0
  v_dot2_f32_bf16 v38, v217, v13, v38
  v_dot2_f32_bf16 v38, v218, v14, v38
  v_dot2_f32_bf16 v38, v219, v15, v38
  v_dot2_f32_bf16 v39, v220, v12, 0
  v_dot2_f32_bf16 v39, v221, v13, v39
  v_dot2_f32_bf16 v39, v222, v14, v39
  v_dot2_f32_bf16 v39, v223, v15, v39
  v_dot2_f32_bf16 v40, v224, v12, 0
  v_dot2_f32_bf16 v40, v225, v13, v40
  v_dot2_f32_bf16 v40, v226, v14, v40
  v_dot2_f32_bf16 v40, v227, v15, v40
  v_dot2_f32_bf16 v41, v228, v12, 0
  v_dot2_f32_bf16 v41, v229, v13, v41
  v_dot2_f32_bf16 v41, v230, v14, v41
  v_dot2_f32_bf16 v41, v231, v15, v41
  v_dot2_f32_bf16 v42, v232, v12, 0
  v_dot2_f32_bf16 v42, v233, v13, v42
  v_dot2_f32_bf16 v42, v234, v14, v42
  v_dot2_f32_bf16 v42, v235, v15, v42
  v_dot2_f32_bf16 v43, v236, v12, 0
  v_dot2_f32_bf16 v43, v237, v13, v43
  v_dot2_f32_bf16 v43, v238, v14, v43
  v_dot2_f32_bf16 v43, v239, v15, v43
  v_dot2_f32_bf16 v44, v240, v12, 0
  v_dot2_f32_bf16 v44, v241, v13, v44
  v_dot2_f32_bf16 v44, v242, v14, v44
  v_dot2_f32_bf16 v44, v243, v15, v44
  v_dot2_f32_bf16 v45, v244, v12, 0
  v_dot2_f32_bf16 v45, v245, v13, v45
  v_dot2_f32_bf16 v45, v246, v14, v45
  v_dot2_f32_bf16 v45, v247, v15, v45
  v_dot2_f32_bf16 v46, v248, v12, 0
  v_dot2_f32_bf16 v46, v249, v13, v46
  v_dot2_f32_bf16 v46, v250, v14, v46
  v_dot2_f32_bf16 v46, v251, v15, v46
  v_dot2_f32_bf16 v47, v252, v12, 0
  v_dot2_f32_bf16 v47, v253, v13, v47
  v_dot2_f32_bf16 v47, v254, v14, v47
  v_dot2_f32_bf16 v47, v255, v15, v47
  v_add_f32_dpp v32, v32, v32 row_ror:8 row_mask:0xf bank_mask:0x3
  v_add_f32_dpp v33, v33, v33 row_ror:8 row_mask:0xf bank_mask:0x3
  v_add_f32_dpp v34, v34, v34 row_ror:8 row_mask:0xf bank_mask:0x3
  v_add_f32_dpp v35, v35, v35 row_ror:8 row_mask:0xf bank_mask:0x3
  v_add_f32_dpp v36, v36, v36 row_ror:8 row_mask:0xf bank_mask:0x3
  v_add_f32_dpp v37, v37, v37 row_ror:8 row_mask:0xf bank_mask:0x3
  v_add_f32_dpp v38, v38, v38 row_ror:8 row_mask:0xf bank_mask:0x3
  v_add_f32_dpp v39, v39, v39 row_ror:8 row_mask:0xf bank_mask:0x3
  v_add_f32_dpp v32, v40, v40 row_ror:8 row_mask:0xf bank_mask:0xc
  v_add_f32_dpp v33, v41, v41 row_ror:8 row_mask:0xf bank_mask:0xc
  v_add_f32_dpp v34, v42, v42 row_ror:8 row_mask:0xf bank_mask:0xc
  v_add_f32_dpp v35, v43, v43 row_ror:8 row_mask:0xf bank_mask:0xc
  v_add_f32_dpp v36, v44, v44 row_ror:8 row_mask:0xf bank_mask:0xc
  v_add_f32_dpp v37, v45, v45 row_ror:8 row_mask:0xf bank_mask:0xc
  v_add_f32_dpp v38, v46, v46 row_ror:8 row_mask:0xf bank_mask:0xc
  v_add_f32_dpp v39, v47, v47 row_ror:8 row_mask:0xf bank_mask:0xc
  v_add_f32_dpp v32, v32, v32 row_shl:4 row_mask:0xf bank_mask:0x5
  v_add_f32_dpp v33, v33, v33 row_shl:4 row_mask:0xf bank_mask:0x5
  v_add_f32_dpp v34, v34, v34 row_shl:4 row_mask:0xf bank_mask:0x5
  v_add_f32_dpp v35, v35, v35 row_shl:4 row_mask:0xf bank_mask:0x5
  v_add_f32_dpp v32, v36, v36 row_shr:4 row_mask:0xf bank_mask:0xa
  v_add_f32_dpp v33, v37, v37 row_shr:4 row_mask:0xf bank_mask:0xa
  v_add_f32_dpp v34, v38, v38 row_shr:4 row_mask:0xf bank_mask:0xa
  v_add_f32_dpp v35, v39, v39 row_shr:4 row_mask:0xf bank_mask:0xa
  s_nop 0
  v_add_f32_dpp v32, v32, v32 quad_perm:[2,3,0,1] row_mask:0xf bank_mask:0xf
  v_add_f32_dpp v33, v33, v33 quad_perm:[2,3,0,1] row_mask:0xf bank_mask:0xf
  v_add_f32_dpp v34, v34, v34 quad_perm:[2,3,0,1] row_mask:0xf bank_mask:0xf
  v_add_f32_dpp v35, v35, v35 quad_perm:[2,3,0,1] row_mask:0xf bank_mask:0xf
  v_cndmask_b32 v32, v32, v34, s[68:69]
  v_cndmask_b32 v33, v33, v35, s[68:69]
  s_nop 0
  v_add_f32_dpp v32, v32, v32 quad_perm:[1,0,3,2] row_mask:0xf bank_mask:0xf
  v_add_f32_dpp v33, v33, v33 quad_perm:[1,0,3,2] row_mask:0xf bank_mask:0xf
  v_cndmask_b32 v32, v32, v33, s[70:71]
  v_cvt_pk_bf16_f32 v32, v32, v32
  v_lshlrev_b32 v32, 16, v32
  v_mul_f32 v32, 0x3db504f3, v32
  v_cvt_pk_bf16_f32 v32, v32, v32
  ds_write_b16 v10, v32 offset:16512
  s_cmp_gt_u32 s63, 6
  s_cbranch_scc1 L_kloop
  v_accvgpr_read_b32 v192, a128
  v_accvgpr_read_b32 v193, a129
  v_accvgpr_read_b32 v194, a130
  v_accvgpr_read_b32 v195, a131
  v_accvgpr_read_b32 v196, a132
  v_accvgpr_read_b32 v197, a133
  v_accvgpr_read_b32 v198, a134
  v_accvgpr_read_b32 v199, a135
  v_accvgpr_read_b32 v200, a136
  v_accvgpr_read_b32 v201, a137
  v_accvgpr_read_b32 v202, a138
  v_accvgpr_read_b32 v203, a139
  v_accvgpr_read_b32 v204, a140
  v_accvgpr_read_b32 v205, a141
  v_accvgpr_read_b32 v206, a142
  v_accvgpr_read_b32 v207, a143
  v_accvgpr_read_b32 v208, a144
  v_accvgpr_read_b32 v209, a145
  v_accvgpr_read_b32 v210, a146
  v_accvgpr_read_b32 v211, a147
  v_accvgpr_read_b32 v212, a148
  v_accvgpr_read_b32 v213, a149
  v_accvgpr_read_b32 v214, a150
  v_accvgpr_read_b32 v215, a151
  v_accvgpr_read_b32 v216, a152
  v_accvgpr_read_b32 v217, a153
  v_accvgpr_read_b32 v218, a154
  v_accvgpr_read_b32 v219, a155
  v_accvgpr_read_b32 v220, a156
  v_accvgpr_read_b32 v221, a157
  v_accvgpr_read_b32 v222, a158
  v_accvgpr_read_b32 v223, a159
  v_accvgpr_read_b32 v224, a160
  v_accvgpr_read_b32 v225, a161
  v_accvgpr_read_b32 v226, a162
  v_accvgpr_read_b32 v227, a163
  v_accvgpr_read_b32 v228, a164
  v_accvgpr_read_b32 v229, a165
  v_accvgpr_read_b32 v230, a166
  v_accvgpr_read_b32 v231, a167
  v_accvgpr_read_b32 v232, a168
  v_accvgpr_read_b32 v233, a169
  v_accvgpr_read_b32 v234, a170
  v_accvgpr_read_b32 v235, a171
  v_accvgpr_read_b32 v236, a172
  v_accvgpr_read_b32 v237, a173
  v_accvgpr_read_b32 v238, a174
  v_accvgpr_read_b32 v239, a175
  v_accvgpr_read_b32 v240, a176
  v_accvgpr_read_b32 v241, a177
  v_accvgpr_read_b32 v242, a178
  v_accvgpr_read_b32 v243, a179
  v_accvgpr_read_b32 v244, a180
  v_accvgpr_read_b32 v245, a181
  v_accvgpr_read_b32 v246, a182
  v_accvgpr_read_b32 v247, a183
  v_accvgpr_read_b32 v248, a184
  v_accvgpr_read_b32 v249, a185
  v_accvgpr_read_b32 v250, a186
  v_accvgpr_read_b32 v251, a187
  v_accvgpr_read_b32 v252, a188
  v_accvgpr_read_b32 v253, a189
  v_accvgpr_read_b32 v254, a190
  v_accvgpr_read_b32 v255, a191
  s_branch L_kloop
L_h1:
  s_branch L_xd
L_h2:
  s_barrier
  v_mov_b32 v9, 1
  buffer_store_byte v9, v6, s[44:47], 0 offen sc1
  s_branch L_xd
L_hb1:
  s_mov_b32 s64, s32
  s_branch L_xd
L_hq1:
  s_add_u32 s82, s82, 6
  v_lshlrev_b32 v10, 3, v0
  ds_read_b64 v[32:33], v10 offset:4096
  ds_read_b64 v[34:35], v10 offset:5120
  ds_read_b64 v[36:37], v10 offset:6144
  ds_read_b64 v[38:39], v10 offset:7168
  s_waitcnt lgkmcnt(0)
  v_add_f32 v32, v32, v34
  v_add_f32 v33, v33, v35
  v_add_f32 v32, v32, v36
  v_add_f32 v33, v33, v37
  v_add_f32 v32, v32, v38
  v_add_f32 v33, v33, v39
  v_cvt_pk_bf16_f32 v32, v32, v33
  ds_bpermute_b32 v12, v48, v32 offset:0
  ds_bpermute_b32 v13, v48, v32 offset:4
  ds_bpermute_b32 v14, v48, v32 offset:8
  ds_bpermute_b32 v15, v48, v32 offset:12
  v_add_u32 v51, 256, v51
  s_lshl_b32 s72, s52, 11
  v_add_u32 v9, s72, v3
  ds_read_b128 v[24:27], v9 offset:15616
  s_lshl_b32 s72, s58, 2
  s_lshl_b32 s73, s52, 10
  s_add_u32 s72, s72, s73
  s_add_u32 s72, s72, 4194304
  s_waitcnt lgkmcnt(0)
  buffer_store_dwordx4 v[24:27], v3, s[40:43], s72 offen sc1
  v_lshlrev_b32 v32, 16, v24
  v_and_b32 v33, 0xffff0000, v24
  v_lshlrev_b32 v34, 16, v25
  v_and_b32 v35, 0xffff0000, v25
  v_lshlrev_b32 v36, 16, v26
  v_and_b32 v37, 0xffff0000, v26
  v_lshlrev_b32 v38, 16, v27
  v_and_b32 v39, 0xffff0000, v27
  v_max3_f32 v20, v32, v33, v34
  v_max3_f32 v20, v35, v36, v20
  v_max3_f32 v20, v37, v38, v20
  v_max_f32 v20, v39, v20
  s_nop 1
  v_max_f32_dpp v20, v20, v20 row_ror:8 row_mask:0xf bank_mask:0xf
  s_nop 1
  v_max_f32_dpp v20, v20, v20 row_ror:4 row_mask:0xf bank_mask:0xf
  s_nop 1
  v_max_f32_dpp v20, v20, v20 row_ror:2 row_mask:0xf bank_mask:0xf
  s_nop 1
  v_max_f32_dpp v20, v20, v20 row_ror:1 row_mask:0xf bank_mask:0xf
  v_mov_b32 v40, v20
  s_nop 1
  v_permlane16_swap_b32 v40, v20
  s_nop 1
  v_max_f32 v20, v20, v40
  v_mov_b32 v40, v20
  s_nop 1
  v_permlane32_swap_b32 v40, v20
  s_nop 1
  v_max_f32 v20, v20, v40
  v_sub_f32 v32, v32, v20
  v_sub_f32 v33, v33, v20
  v_sub_f32 v34, v34, v20
  v_sub_f32 v35, v35, v20
  v_sub_f32 v36, v36, v20
  v_sub_f32 v37, v37, v20
  v_sub_f32 v38, v38, v20
  v_sub_f32 v39, v39, v20
  v_mul_f32 v32, 0x3fb8aa3b, v32
  v_mul_f32 v33, 0x3fb8aa3b, v33
  v_mul_f32 v34, 0x3fb8aa3b, v34
  v_mul_f32 v35, 0x3fb8aa3b, v35
  v_mul_f32 v36, 0x3fb8aa3b, v36
  v_mul_f32 v37, 0x3fb8aa3b, v37
  v_mul_f32 v38, 0x3fb8aa3b, v38
  v_mul_f32 v39, 0x3fb8aa3b, v39
  v_exp_f32 v32, v32
  v_exp_f32 v33, v33
  v_exp_f32 v34, v34
  v_exp_f32 v35, v35
  v_exp_f32 v36, v36
  v_exp_f32 v37, v37
  v_exp_f32 v38, v38
  v_exp_f32 v39, v39
  v_add_f32 v32, v32, v36
  v_add_f32 v33, v33, v37
  v_add_f32 v34, v34, v38
  v_add_f32 v35, v35, v39
  v_add_f32 v32, v32, v34
  v_add_f32 v33, v33, v35
  v_add_f32 v21, v32, v33
  s_nop 1
  v_add_f32_dpp v21, v21, v21 row_ror:8 row_mask:0xf bank_mask:0xf
  s_nop 1
  v_add_f32_dpp v21, v21, v21 row_ror:4 row_mask:0xf bank_mask:0xf
  s_nop 1
  v_add_f32_dpp v21, v21, v21 row_ror:2 row_mask:0xf bank_mask:0xf
  s_nop 1
  v_add_f32_dpp v21, v21, v21 row_ror:1 row_mask:0xf bank_mask:0xf
  v_mov_b32 v40, v21
  s_nop 1
  v_permlane16_swap_b32 v40, v21
  s_nop 1
  v_add_f32 v21, v21, v40
  v_mov_b32 v40, v21
  s_nop 1
  v_permlane32_swap_b32 v40, v21
  s_nop 1
  v_add_f32 v21, v21, v40
  s_sub_u32 s72, s72, 4194304
  s_lshr_b32 s72, s72, 7
  s_add_u32 s72, s72, 589824
  buffer_store_dwordx2 v[20:21], v5, s[40:43], s72 offen sc1
  s_branch L_kloop
L_hv:
  s_mov_b32 s28, s8
  s_mov_b32 s29, s9
  s_mov_b32 s64, s32
  s_branch L_xd
L_kend:
  v_and_b32 v63, 0x7c, v63
  s_lshl_b32 s72, s52, 11
  v_add_u32 v51, s72, v63
  ds_read_b32 v62, v51 offset:16640
  v_add_u32 v9, s72, v3
  ds_read_b128 v[24:27], v9 offset:16640
  v_and_b32 v12, 1, v0
  v_lshlrev_b32 v12, 4, v12
  s_mov_b32 s63, 0
  v_lshrrev_b32 v9, 3, v2
  v_and_b32 v10, 7, v2
  v_lshl_add_u32 v9, v9, 8, v10
  s_lshl_b32 s72, s54, 3
  v_add_u32 v9, s72, v9
  v_lshlrev_b32 v57, 10, v9
  v_lshl_add_u32 v56, v1, 4, v57
  s_lshr_b32 s72, s53, 2
  s_lshl_b32 s72, s72, 8
  s_lshl_b32 s73, s52, 6
  s_add_u32 s72, s72, s73
  v_add_u32 v56, s72, v56
  s_lshl_b32 s72, s54, 13
  s_lshl_b32 s73, s52, 11
  s_add_u32 s72, s72, s73
  s_add_u32 s72, s72, 1048576
  v_add_u32 v58, s72, v3
  s_lshl_b32 s72, s52, 8
  v_add_u32 v13, s72, v55
  v_mov_b32 v59, 1.0
  s_mov_b32 s35, s64
  s_mov_b32 s59, s64
  s_waitcnt lgkmcnt(0)
  v_lshlrev_b32 v32, 16, v24
  v_and_b32 v33, 0xffff0000, v24
  v_lshlrev_b32 v34, 16, v25
  v_and_b32 v35, 0xffff0000, v25
  v_lshlrev_b32 v36, 16, v26
  v_and_b32 v37, 0xffff0000, v26
  v_lshlrev_b32 v38, 16, v27
  v_and_b32 v39, 0xffff0000, v27
  v_max3_f32 v7, v32, v33, v34
  v_max3_f32 v7, v35, v36, v7
  v_max3_f32 v7, v37, v38, v7
  v_max_f32 v7, v39, v7
  s_nop 1
  v_max_f32_dpp v7, v7, v7 row_ror:8 row_mask:0xf bank_mask:0xf
  s_nop 1
  v_max_f32_dpp v7, v7, v7 row_ror:4 row_mask:0xf bank_mask:0xf
  s_nop 1
  v_max_f32_dpp v7, v7, v7 row_ror:2 row_mask:0xf bank_mask:0xf
  s_nop 1
  v_max_f32_dpp v7, v7, v7 row_ror:1 row_mask:0xf bank_mask:0xf
  v_mov_b32 v40, v7
  s_nop 1
  v_permlane16_swap_b32 v40, v7
  s_nop 1
  v_max_f32 v7, v7, v40
  v_mov_b32 v40, v7
  s_nop 1
  v_permlane32_swap_b32 v40, v7
  s_nop 1
  v_max_f32 v7, v7, v40
  v_sub_f32 v32, v32, v7
  v_sub_f32 v33, v33, v7
  v_sub_f32 v34, v34, v7
  v_sub_f32 v35, v35, v7
  v_sub_f32 v36, v36, v7
  v_sub_f32 v37, v37, v7
  v_sub_f32 v38, v38, v7
  v_sub_f32 v39, v39, v7
  v_mul_f32 v32, 0x3fb8aa3b, v32
  v_mul_f32 v33, 0x3fb8aa3b, v33
  v_mul_f32 v34, 0x3fb8aa3b, v34
  v_mul_f32 v35, 0x3fb8aa3b, v35
  v_mul_f32 v36, 0x3fb8aa3b, v36
  v_mul_f32 v37, 0x3fb8aa3b, v37
  v_mul_f32 v38, 0x3fb8aa3b, v38
  v_mul_f32 v39, 0x3fb8aa3b, v39
  v_exp_f32 v32, v32
  v_exp_f32 v33, v33
  v_exp_f32 v34, v34
  v_exp_f32 v35, v35
  v_exp_f32 v36, v36
  v_exp_f32 v37, v37
  v_exp_f32 v38, v38
  v_exp_f32 v39, v39
  v_add_f32 v32, v32, v36
  v_add_f32 v33, v33, v37
  v_add_f32 v34, v34, v38
  v_add_f32 v35, v35, v39
  v_add_f32 v32, v32, v34
  v_add_f32 v33, v33, v35
  v_add_f32 v8, v32, v33
  s_nop 1
  v_add_f32_dpp v8, v8, v8 row_ror:8 row_mask:0xf bank_mask:0xf
  s_nop 1
  v_add_f32_dpp v8, v8, v8 row_ror:4 row_mask:0xf bank_mask:0xf
  s_nop 1
  v_add_f32_dpp v8, v8, v8 row_ror:2 row_mask:0xf bank_mask:0xf
  s_nop 1
  v_add_f32_dpp v8, v8, v8 row_ror:1 row_mask:0xf bank_mask:0xf
  v_mov_b32 v40, v8
  s_nop 1
  v_permlane16_swap_b32 v40, v8
  s_nop 1
  v_add_f32 v8, v8, v40
  v_mov_b32 v40, v8
  s_nop 1
  v_permlane32_swap_b32 v40, v8
  s_nop 1
  v_add_f32 v8, v8, v40
  .p2align 6
L_vloop:
  v_lshrrev_b32 v32, v12, v62
  v_lshlrev_b32 v32, 16, v32
  v_sub_f32 v35, v32, v7
  v_mul_f32 v35, 0x3fb8aa3b, v35
  v_exp_f32 v35, v35
  s_cmp_ge_u32 s63, 7
  s_cbranch_scc1 L_sg
  v_add_u32 v51, 128, v51
  ds_read_b32 v62, v51 offset:16640
  s_branch L_sreq
L_sg:
  s_cmp_ge_u32 s64, 268435456
  s_cbranch_scc1 L_vlast
  s_bfe_u32 s72, s64, 65552
  s_lshl_b32 s72, s72, 12
  s_bfe_u32 s73, s64, 65553
  s_lshl_b32 s73, s73, 13
  s_or_b32 s72, s72, s73
  s_bfe_u32 s73, s64, 65557
  s_lshl_b32 s73, s73, 14
  s_or_b32 s72, s72, s73
  s_bfe_u32 s73, s64, 196626
  s_lshl_b32 s73, s73, 7
  s_add_u32 s72, s72, s73
  s_add_u32 s72, s72, s33
  buffer_load_dword v62, v63, s[40:43], s72 offen sc1
L_sreq:
  s_cmp_lt_u32 s63, 6
  s_cbranch_scc1 L_sdone
  s_cmp_lg_u32 s52, 0
  s_cbranch_scc1 L_sdone
  v_mov_b32 v50, 1
  buffer_atomic_add v50, v5, s[40:43], s66 offen sc0 sc1
L_sdone:
  v_mul_f32 v35, v35, v59
  v_cvt_pk_bf16_f32 v35, v35, v35
  s_nop 1
  v_and_b32_dpp v20, v35, v16 row_newbcast:0 row_mask:0xf bank_mask:0xf
  v_and_b32_dpp v21, v35, v17 row_newbcast:0 row_mask:0xf bank_mask:0xf
  v_and_b32_dpp v22, v35, v18 row_newbcast:0 row_mask:0xf bank_mask:0xf
  v_and_b32_dpp v23, v35, v19 row_newbcast:0 row_mask:0xf bank_mask:0xf
  v_and_b32_dpp v24, v35, v16 row_newbcast:1 row_mask:0xf bank_mask:0xf
  v_and_b32_dpp v25, v35, v17 row_newbcast:1 row_mask:0xf bank_mask:0xf
  v_and_b32_dpp v26, v35, v18 row_newbcast:1 row_mask:0xf bank_mask:0xf
  v_and_b32_dpp v27, v35, v19 row_newbcast:1 row_mask:0xf bank_mask:0xf
  s_waitcnt vmcnt(15)
  v_mfma_f32_16x16x32_bf16 v[28:31], v[20:23], v[64:67], v[28:31]
  buffer_load_dwordx4 v[64:67], v3, s[28:31], s35 offen nt
  v_and_b32_dpp v20, v35, v16 row_newbcast:2 row_mask:0xf bank_mask:0xf
  v_and_b32_dpp v21, v35, v17 row_newbcast:2 row_mask:0xf bank_mask:0xf
  v_and_b32_dpp v22, v35, v18 row_newbcast:2 row_mask:0xf bank_mask:0xf
  v_and_b32_dpp v23, v35, v19 row_newbcast:2 row_mask:0xf bank_mask:0xf
  s_waitcnt vmcnt(15)
  v_mfma_f32_16x16x32_bf16 v[28:31], v[24:27], v[68:71], v[28:31]
  s_add_u32 s65, s35, 4096
  buffer_load_dwordx4 v[68:71], v3, s[28:31], s65 offen nt
  v_and_b32_dpp v24, v35, v16 row_newbcast:3 row_mask:0xf bank_mask:0xf
  v_and_b32_dpp v25, v35, v17 row_newbcast:3 row_mask:0xf bank_mask:0xf
  v_and_b32_dpp v26, v35, v18 row_newbcast:3 row_mask:0xf bank_mask:0xf
  v_and_b32_dpp v27, v35, v19 row_newbcast:3 row_mask:0xf bank_mask:0xf
  s_waitcnt vmcnt(15)
  v_mfma_f32_16x16x32_bf16 v[28:31], v[20:23], v[72:75], v[28:31]
  s_add_u32 s65, s35, 8192
  buffer_load_dwordx4 v[72:75], v3, s[28:31], s65 offen nt
  v_and_b32_dpp v20, v35, v16 row_newbcast:4 row_mask:0xf bank_mask:0xf
  v_and_b32_dpp v21, v35, v17 row_newbcast:4 row_mask:0xf bank_mask:0xf
  v_and_b32_dpp v22, v35, v18 row_newbcast:4 row_mask:0xf bank_mask:0xf
  v_and_b32_dpp v23, v35, v19 row_newbcast:4 row_mask:0xf bank_mask:0xf
  s_waitcnt vmcnt(15)
  v_mfma_f32_16x16x32_bf16 v[28:31], v[24:27], v[76:79], v[28:31]
  s_add_u32 s65, s35, 12288
  buffer_load_dwordx4 v[76:79], v3, s[28:31], s65 offen nt
  v_and_b32_dpp v24, v35, v16 row_newbcast:5 row_mask:0xf bank_mask:0xf
  v_and_b32_dpp v25, v35, v17 row_newbcast:5 row_mask:0xf bank_mask:0xf
  v_and_b32_dpp v26, v35, v18 row_newbcast:5 row_mask:0xf bank_mask:0xf
  v_and_b32_dpp v27, v35, v19 row_newbcast:5 row_mask:0xf bank_mask:0xf
  s_waitcnt vmcnt(15)
  v_mfma_f32_16x16x32_bf16 v[28:31], v[20:23], v[80:83], v[28:31]
  s_add_u32 s65, s35, 16384
  buffer_load_dwordx4 v[80:83], v3, s[28:31], s65 offen nt
  v_and_b32_dpp v20, v35, v16 row_newbcast:6 row_mask:0xf bank_mask:0xf
  v_and_b32_dpp v21, v35, v17 row_newbcast:6 row_mask:0xf bank_mask:0xf
  v_and_b32_dpp v22, v35, v18 row_newbcast:6 row_mask:0xf bank_mask:0xf
  v_and_b32_dpp v23, v35, v19 row_newbcast:6 row_mask:0xf bank_mask:0xf
  s_waitcnt vmcnt(15)
  v_mfma_f32_16x16x32_bf16 v[28:31], v[24:27], v[84:87], v[28:31]
  s_add_u32 s65, s35, 20480
  buffer_load_dwordx4 v[84:87], v3, s[28:31], s65 offen nt
  v_and_b32_dpp v24, v35, v16 row_newbcast:7 row_mask:0xf bank_mask:0xf
  v_and_b32_dpp v25, v35, v17 row_newbcast:7 row_mask:0xf bank_mask:0xf
  v_and_b32_dpp v26, v35, v18 row_newbcast:7 row_mask:0xf bank_mask:0xf
  v_and_b32_dpp v27, v35, v19 row_newbcast:7 row_mask:0xf bank_mask:0xf
  s_waitcnt vmcnt(15)
  v_mfma_f32_16x16x32_bf16 v[28:31], v[20:23], v[88:91], v[28:31]
  s_add_u32 s65, s35, 24576
  buffer_load_dwordx4 v[88:91], v3, s[28:31], s65 offen nt
  v_and_b32_dpp v20, v35, v16 row_newbcast:8 row_mask:0xf bank_mask:0xf
  v_and_b32_dpp v21, v35, v17 row_newbcast:8 row_mask:0xf bank_mask:0xf
  v_and_b32_dpp v22, v35, v18 row_newbcast:8 row_mask:0xf bank_mask:0xf
  v_and_b32_dpp v23, v35, v19 row_newbcast:8 row_mask:0xf bank_mask:0xf
  s_waitcnt vmcnt(15)
  v_mfma_f32_16x16x32_bf16 v[28:31], v[24:27], v[92:95], v[28:31]
  s_add_u32 s65, s35, 28672
  buffer_load_dwordx4 v[92:95], v3, s[28:31], s65 offen nt
  v_and_b32_dpp v24, v35, v16 row_newbcast:9 row_mask:0xf bank_mask:0xf
  v_and_b32_dpp v25, v35, v17 row_newbcast:9 row_mask:0xf bank_mask:0xf
  v_and_b32_dpp v26, v35, v18 row_newbcast:9 row_mask:0xf bank_mask:0xf
  v_and_b32_dpp v27, v35, v19 row_newbcast:9 row_mask:0xf bank_mask:0xf
  s_waitcnt vmcnt(15)
  v_mfma_f32_16x16x32_bf16 v[28:31], v[20:23], v[96:99], v[28:31]
  s_add_u32 s65, s59, 32768
  buffer_load_dwordx4 v[96:99], v3, s[28:31], s65 offen nt
  v_and_b32_dpp v20, v35, v16 row_newbcast:10 row_mask:0xf bank_mask:0xf
  v_and_b32_dpp v21, v35, v17 row_newbcast:10 row_mask:0xf bank_mask:0xf
  v_and_b32_dpp v22, v35, v18 row_newbcast:10 row_mask:0xf bank_mask:0xf
  v_and_b32_dpp v23, v35, v19 row_newbcast:10 row_mask:0xf bank_mask:0xf
  s_waitcnt vmcnt(15)
  v_mfma_f32_16x16x32_bf16 v[28:31], v[24:27], v[100:103], v[28:31]
  s_add_u32 s65, s59, 36864
  buffer_load_dwordx4 v[100:103], v3, s[28:31], s65 offen nt
  v_and_b32_dpp v24, v35, v16 row_newbcast:11 row_mask:0xf bank_mask:0xf
  v_and_b32_dpp v25, v35, v17 row_newbcast:11 row_mask:0xf bank_mask:0xf
  v_and_b32_dpp v26, v35, v18 row_newbcast:11 row_mask:0xf bank_mask:0xf
  v_and_b32_dpp v27, v35, v19 row_newbcast:11 row_mask:0xf bank_mask:0xf
  s_waitcnt vmcnt(15)
  v_mfma_f32_16x16x32_bf16 v[28:31], v[20:23], v[104:107], v[28:31]
  s_add_u32 s65, s59, 40960
  buffer_load_dwordx4 v[104:107], v3, s[28:31], s65 offen nt
  v_and_b32_dpp v20, v35, v16 row_newbcast:12 row_mask:0xf bank_mask:0xf
  v_and_b32_dpp v21, v35, v17 row_newbcast:12 row_mask:0xf bank_mask:0xf
  v_and_b32_dpp v22, v35, v18 row_newbcast:12 row_mask:0xf bank_mask:0xf
  v_and_b32_dpp v23, v35, v19 row_newbcast:12 row_mask:0xf bank_mask:0xf
  s_waitcnt vmcnt(15)
  v_mfma_f32_16x16x32_bf16 v[28:31], v[24:27], v[108:111], v[28:31]
  s_add_u32 s65, s59, 45056
  buffer_load_dwordx4 v[108:111], v3, s[28:31], s65 offen nt
  v_and_b32_dpp v24, v35, v16 row_newbcast:13 row_mask:0xf bank_mask:0xf
  v_and_b32_dpp v25, v35, v17 row_newbcast:13 row_mask:0xf bank_mask:0xf
  v_and_b32_dpp v26, v35, v18 row_newbcast:13 row_mask:0xf bank_mask:0xf
  v_and_b32_dpp v27, v35, v19 row_newbcast:13 row_mask:0xf bank_mask:0xf
  s_waitcnt vmcnt(15)
  v_mfma_f32_16x16x32_bf16 v[28:31], v[20:23], v[112:115], v[28:31]
  s_add_u32 s65, s59, 49152
  buffer_load_dwordx4 v[112:115], v3, s[28:31], s65 offen nt
  v_and_b32_dpp v20, v35, v16 row_newbcast:14 row_mask:0xf bank_mask:0xf
  v_and_b32_dpp v21, v35, v17 row_newbcast:14 row_mask:0xf bank_mask:0xf
  v_and_b32_dpp v22, v35, v18 row_newbcast:14 row_mask:0xf bank_mask:0xf
  v_and_b32_dpp v23, v35, v19 row_newbcast:14 row_mask:0xf bank_mask:0xf
  s_waitcnt vmcnt(15)
  v_mfma_f32_16x16x32_bf16 v[28:31], v[24:27], v[116:119], v[28:31]
  s_add_u32 s65, s59, 53248
  buffer_load_dwordx4 v[116:119], v3, s[28:31], s65 offen nt
  v_and_b32_dpp v24, v35, v16 row_newbcast:15 row_mask:0xf bank_mask:0xf
  v_and_b32_dpp v25, v35, v17 row_newbcast:15 row_mask:0xf bank_mask:0xf
  v_and_b32_dpp v26, v35, v18 row_newbcast:15 row_mask:0xf bank_mask:0xf
  v_and_b32_dpp v27, v35, v19 row_newbcast:15 row_mask:0xf bank_mask:0xf
  s_waitcnt vmcnt(15)
  v_mfma_f32_16x16x32_bf16 v[28:31], v[20:23], v[120:123], v[28:31]
  s_add_u32 s65, s59, 57344
  buffer_load_dwordx4 v[120:123], v3, s[28:31], s65 offen nt
  s_nop 1
  s_waitcnt vmcnt(15)
  v_mfma_f32_16x16x32_bf16 v[28:31], v[24:27], v[124:127], v[28:31]
  s_add_u32 s65, s59, 61440
  buffer_load_dwordx4 v[124:127], v3, s[28:31], s65 offen nt
  s_add_u32 s63, s63, 1
  s_waitcnt lgkmcnt(0)
  s_cmp_ge_u32 s63, 7
  s_cbranch_scc1 L_dyn
  s_add_u32 s35, s35, 262144
  s_mov_b32 s59, s35
L_vhooks:
  s_cmp_gt_u32 s63, 8
  s_cbranch_scc1 L_vloop
  s_cmp_eq_u32 s63, 8
  s_cbranch_scc1 L_comb
  s_cmp_lg_u32 s52, 0
  s_cbranch_scc1 L_vloop
  s_cmp_eq_u32 s63, 4
  s_cbranch_scc1 L_hfl
  s_cmp_eq_u32 s63, 5
  s_cbranch_scc1 L_hck
  s_cmp_eq_u32 s63, 6
  s_cbranch_scc1 L_hst
  s_branch L_vloop
L_dyn:
  s_lshl_b32 s73, s63, 2
  v_mov_b32 v9, s73
  s_cmp_lg_u32 s52, 0
  s_cbranch_scc1 L_fol
  v_readfirstlane_b32 s72, v50
  s_nop 3
  s_min_u32 s72, s72, 0xffff
  v_mov_b32 v50, s72
  ds_write_b32 v9, v50 offset:15104
  s_branch L_got
L_fol:
  ds_read_b32 v50, v9 offset:15104
  s_waitcnt lgkmcnt(0)
  v_readfirstlane_b32 s72, v50
  s_nop 3
  s_cmp_eq_u32 s72, -1
  s_cbranch_scc1 L_fol
L_got:
  s_sub_u32 s73, s72, 52
  s_min_u32 s73, s73, 3
  s_lshl_b32 s76, s73, 5
  s_add_u32 s76, s76, s54
  s_cmp_lt_u32 s54, 24
  s_cselect_b32 s73, 2, 1
  s_cmp_ge_u32 s72, 52
  s_cselect_b32 s73, s73, 0
  s_sub_u32 s72, s72, s73
  s_cmp_lt_u32 s76, 56
  s_cselect_b32 s72, 0xffff, s72
  s_sub_u32 s73, s72, 56
  s_lshr_b32 s74, s73, 1
  s_add_u32 s74, s74, 56
  s_and_b32 s80, s73, 1
  s_cmp_ge_u32 s72, 56
  s_cselect_b32 s72, s74, s72
  s_cselect_b32 s80, s80, 2
  s_bfe_u32 s73, s72, 65536
  s_lshl_b32 s73, s73, 16
  s_bfe_u32 s74, s72, 65537
  s_lshl_b32 s74, s74, 17
  s_or_b32 s73, s73, s74
  s_bfe_u32 s74, s72, 65538
  s_lshl_b32 s74, s74, 21
  s_or_b32 s73, s73, s74
  s_lshr_b32 s74, s72, 3
  s_lshl_b32 s74, s74, 18
  s_add_u32 s73, s73, s74
  s_add_u32 s73, s73, s57
  s_cmp_ge_u32 s72, 64
  s_cselect_b32 s64, 268435456, s73
  s_cmp_eq_u32 s80, 1
  s_cselect_b32 s35, 268435456, s64
  s_cmp_eq_u32 s80, 0
  s_cselect_b32 s59, 268435456, s64
  s_branch L_vhooks
L_hfl:
  buffer_load_dword v52, v55, s[44:47], 0 offen sc1
  s_branch L_vloop
L_hck:
  v_cmp_ne_u32 vcc, 0x01010101, v52
  s_nop 4
  s_cbranch_vccz L_hok
  s_sub_u32 s83, s83, 1
  s_cbranch_scc1 L_hok
  s_sleep 4
  buffer_load_dword v52, v55, s[44:47], 0 offen sc1
  s_waitcnt vmcnt(0)
  s_branch L_hck
L_hok:
  v_and_b32 v9, 31, v0
  v_lshlrev_b32 v9, 3, v9
  s_lshl_b32 s72, s54, 8
  s_add_u32 s72, s72, 589824
  buffer_load_dwordx2 v[14:15], v9, s[40:43], s72 offen sc1
  s_cmp_eq_u32 s77, 0
  s_cbranch_scc1 L_vloop
  global_load_ushort v11, v53, s[4:5]
  s_branch L_vloop
L_hst:
  v_mov_b32 v32, v14
  s_nop 1
  v_max_f32_dpp v32, v32, v32 row_ror:8 row_mask:0xf bank_mask:0xf
  s_nop 1
  v_max_f32_dpp v32, v32, v32 row_ror:4 row_mask:0xf bank_mask:0xf
  s_nop 1
  v_max_f32_dpp v32, v32, v32 row_ror:2 row_mask:0xf bank_mask:0xf
  s_nop 1
  v_max_f32_dpp v32, v32, v32 row_ror:1 row_mask:0xf bank_mask:0xf
  v_mov_b32 v33, v32
  s_nop 1
  v_permlane16_swap_b32 v33, v32
  s_nop 1
  v_max_f32 v32, v32, v33
  v_sub_f32 v14, v14, v32
  v_mul_f32 v14, 0x3fb8aa3b, v14
  v_exp_f32 v14, v14
  s_nop 0
  v_mul_f32 v15, v14, v15
  v_mov_b32 v14, v32
  s_nop 1
  v_add_f32_dpp v15, v15, v15 row_ror:8 row_mask:0xf bank_mask:0xf
  s_nop 1
  v_add_f32_dpp v15, v15, v15 row_ror:4 row_mask:0xf bank_mask:0xf
  s_nop 1
  v_add_f32_dpp v15, v15, v15 row_ror:2 row_mask:0xf bank_mask:0xf
  s_nop 1
  v_add_f32_dpp v15, v15, v15 row_ror:1 row_mask:0xf bank_mask:0xf
  v_mov_b32 v33, v15
  s_nop 1
  v_permlane16_swap_b32 v33, v15
  s_nop 1
  v_add_f32 v15, v15, v33
  v_rcp_f32 v15, v15
  v_mov_b32 v32, 0
  ds_write_b64 v32, v[14:15] offset:12352
  s_branch L_vloop
L_vlast:
  buffer_load_dwordx2 v[148:149], v57, s[40:43], 0 offen offset:512 sc1
  global_load_dwordx4 a[64:67], v60, s[12:13] offset:0 nt
  global_load_dwordx4 a[68:71], v60, s[12:13] offset:1024 nt
  global_load_dwordx4 a[72:75], v60, s[12:13] offset:2048 nt
  global_load_dwordx4 a[76:79], v60, s[12:13] offset:3072 nt
  s_cmp_lt_u32 s76, 56
  s_cselect_b32 s38, 1835008, 0
  v_lshrrev_b32 v9, 2, v0
  s_movk_i32 s73, 3584
  v_mul_u32_u24 v9, s73, v9
  v_and_b32 v10, 0x30, v3
  s_mul_i32 s73, s52, 458752
  s_lshl_b32 s74, s76, 6
  s_add_u32 s73, s73, s74
  v_add3_u32 v9, v9, v10, s73
  v_mul_f32 v35, v35, v59
  v_cvt_pk_bf16_f32 v35, v35, v35
  s_nop 1
  v_and_b32_dpp v20, v35, v16 row_newbcast:0 row_mask:0xf bank_mask:0xf
  v_and_b32_dpp v21, v35, v17 row_newbcast:0 row_mask:0xf bank_mask:0xf
  v_and_b32_dpp v22, v35, v18 row_newbcast:0 row_mask:0xf bank_mask:0xf
  v_and_b32_dpp v23, v35, v19 row_newbcast:0 row_mask:0xf bank_mask:0xf
  v_and_b32_dpp v24, v35, v16 row_newbcast:1 row_mask:0xf bank_mask:0xf
  v_and_b32_dpp v25, v35, v17 row_newbcast:1 row_mask:0xf bank_mask:0xf
  v_and_b32_dpp v26, v35, v18 row_newbcast:1 row_mask:0xf bank_mask:0xf
  v_and_b32_dpp v27, v35, v19 row_newbcast:1 row_mask:0xf bank_mask:0xf
  s_waitcnt vmcnt(20)
  v_mfma_f32_16x16x32_bf16 v[28:31], v[20:23], v[64:67], v[28:31]
  s_mov_b32 s36, s16
  s_mov_b32 s37, s17
  s_mov_b32 s72, 0
  buffer_load_dwordx4 a[80:83], v9, s[36:39], s72 offen
  v_and_b32_dpp v20, v35, v16 row_newbcast:2 row_mask:0xf bank_mask:0xf
  v_and_b32_dpp v21, v35, v17 row_newbcast:2 row_mask:0xf bank_mask:0xf
  v_and_b32_dpp v22, v35, v18 row_newbcast:2 row_mask:0xf bank_mask:0xf
  v_and_b32_dpp v23, v35, v19 row_newbcast:2 row_mask:0xf bank_mask:0xf
  s_waitcnt vmcnt(20)
  v_mfma_f32_16x16x32_bf16 v[28:31], v[24:27], v[68:71], v[28:31]
  s_mov_b32 s72, 57344
  buffer_load_dwordx4 a[84:87], v9, s[36:39], s72 offen
  v_and_b32_dpp v24, v35, v16 row_newbcast:3 row_mask:0xf bank_mask:0xf
  v_and_b32_dpp v25, v35, v17 row_newbcast:3 row_mask:0xf bank_mask:0xf
  v_and_b32_dpp v26, v35, v18 row_newbcast:3 row_mask:0xf bank_mask:0xf
  v_and_b32_dpp v27, v35, v19 row_newbcast:3 row_mask:0xf bank_mask:0xf
  s_waitcnt vmcnt(20)
  v_mfma_f32_16x16x32_bf16 v[28:31], v[20:23], v[72:75], v[28:31]
  s_mov_b32 s72, 114688
  buffer_load_dwordx4 a[88:91], v9, s[36:39], s72 offen
  v_and_b32_dpp v20, v35, v16 row_newbcast:4 row_mask:0xf bank_mask:0xf
  v_and_b32_dpp v21, v35, v17 row_newbcast:4 row_mask:0xf bank_mask:0xf
  v_and_b32_dpp v22, v35, v18 row_newbcast:4 row_mask:0xf bank_mask:0xf
  v_and_b32_dpp v23, v35, v19 row_newbcast:4 row_mask:0xf bank_mask:0xf
  s_waitcnt vmcnt(20)
  v_mfma_f32_16x16x32_bf16 v[28:31], v[24:27], v[76:79], v[28:31]
  s_mov_b32 s72, 172032
  buffer_load_dwordx4 a[92:95], v9, s[36:39], s72 offen
  v_and_b32_dpp v24, v35, v16 row_newbcast:5 row_mask:0xf bank_mask:0xf
  v_and_b32_dpp v25, v35, v17 row_newbcast:5 row_mask:0xf bank_mask:0xf
  v_and_b32_dpp v26, v35, v18 row_newbcast:5 row_mask:0xf bank_mask:0xf
  v_and_b32_dpp v27, v35, v19 row_newbcast:5 row_mask:0xf bank_mask:0xf
  s_waitcnt vmcnt(20)
  v_mfma_f32_16x16x32_bf16 v[28:31], v[20:23], v[80:83], v[28:31]
  s_mov_b32 s72, 229376
  buffer_load_dwordx4 a[96:99], v9, s[36:39], s72 offen
  v_and_b32_dpp v20, v35, v16 row_newbcast:6 row_mask:0xf bank_mask:0xf
  v_and_b32_dpp v21, v35, v17 row_newbcast:6 row_mask:0xf bank_mask:0xf
  v_and_b32_dpp v22, v35, v18 row_newbcast:6 row_mask:0xf bank_mask:0xf
  v_and_b32_dpp v23, v35, v19 row_newbcast:6 row_mask:0xf bank_mask:0xf
  s_waitcnt vmcnt(20)
  v_mfma_f32_16x16x32_bf16 v[28:31], v[24:27], v[84:87], v[28:31]
  s_mov_b32 s72, 286720
  buffer_load_dwordx4 a[100:103], v9, s[36:39], s72 offen
  v_and_b32_dpp v24, v35, v16 row_newbcast:7 row_mask:0xf bank_mask:0xf
  v_and_b32_dpp v25, v35, v17 row_newbcast:7 row_mask:0xf bank_mask:0xf
  v_and_b32_dpp v26, v35, v18 row_newbcast:7 row_mask:0xf bank_mask:0xf
  v_and_b32_dpp v27, v35, v19 row_newbcast:7 row_mask:0xf bank_mask:0xf
  s_waitcnt vmcnt(20)
  v_mfma_f32_16x16x32_bf16 v[28:31], v[20:23], v[88:91], v[28:31]
  s_mov_b32 s72, 344064
  buffer_load_dwordx4 a[104:107], v9, s[36:39], s72 offen
  v_and_b32_dpp v20, v35, v16 row_newbcast:8 row_mask:0xf bank_mask:0xf
  v_and_b32_dpp v21, v35, v17 row_newbcast:8 row_mask:0xf bank_mask:0xf
  v_and_b32_dpp v22, v35, v18 row_newbcast:8 row_mask:0xf bank_mask:0xf
  v_and_b32_dpp v23, v35, v19 row_newbcast:8 row_mask:0xf bank_mask:0xf
  s_waitcnt vmcnt(20)
  v_mfma_f32_16x16x32_bf16 v[28:31], v[24:27], v[92:95], v[28:31]
  s_mov_b32 s72, 401408
  buffer_load_dwordx4 a[108:111], v9, s[36:39], s72 offen
  v_and_b32_dpp v24, v35, v16 row_newbcast:9 row_mask:0xf bank_mask:0xf
  v_and_b32_dpp v25, v35, v17 row_newbcast:9 row_mask:0xf bank_mask:0xf
  v_and_b32_dpp v26, v35, v18 row_newbcast:9 row_mask:0xf bank_mask:0xf
  v_and_b32_dpp v27, v35, v19 row_newbcast:9 row_mask:0xf bank_mask:0xf
  s_waitcnt vmcnt(20)
  v_mfma_f32_16x16x32_bf16 v[28:31], v[20:23], v[96:99], v[28:31]
  s_mov_b32 s36, s18
  s_mov_b32 s37, s19
  s_mov_b32 s72, 0
  buffer_load_dwordx4 a[112:115], v9, s[36:39], s72 offen
  v_and_b32_dpp v20, v35, v16 row_newbcast:10 row_mask:0xf bank_mask:0xf
  v_and_b32_dpp v21, v35, v17 row_newbcast:10 row_mask:0xf bank_mask:0xf
  v_and_b32_dpp v22, v35, v18 row_newbcast:10 row_mask:0xf bank_mask:0xf
  v_and_b32_dpp v23, v35, v19 row_newbcast:10 row_mask:0xf bank_mask:0xf
  s_waitcnt vmcnt(20)
  v_mfma_f32_16x16x32_bf16 v[28:31], v[24:27], v[100:103], v[28:31]
  s_mov_b32 s72, 57344
  buffer_load_dwordx4 a[116:119], v9, s[36:39], s72 offen
  v_and_b32_dpp v24, v35, v16 row_newbcast:11 row_mask:0xf bank_mask:0xf
  v_and_b32_dpp v25, v35, v17 row_newbcast:11 row_mask:0xf bank_mask:0xf
  v_and_b32_dpp v26, v35, v18 row_newbcast:11 row_mask:0xf bank_mask:0xf
  v_and_b32_dpp v27, v35, v19 row_newbcast:11 row_mask:0xf bank_mask:0xf
  s_waitcnt vmcnt(20)
  v_mfma_f32_16x16x32_bf16 v[28:31], v[20:23], v[104:107], v[28:31]
  s_mov_b32 s72, 114688
  buffer_load_dwordx4 a[120:123], v9, s[36:39], s72 offen
  v_and_b32_dpp v20, v35, v16 row_newbcast:12 row_mask:0xf bank_mask:0xf
  v_and_b32_dpp v21, v35, v17 row_newbcast:12 row_mask:0xf bank_mask:0xf
  v_and_b32_dpp v22, v35, v18 row_newbcast:12 row_mask:0xf bank_mask:0xf
  v_and_b32_dpp v23, v35, v19 row_newbcast:12 row_mask:0xf bank_mask:0xf
  s_waitcnt vmcnt(20)
  v_mfma_f32_16x16x32_bf16 v[28:31], v[24:27], v[108:111], v[28:31]
  s_mov_b32 s72, 172032
  buffer_load_dwordx4 a[124:127], v9, s[36:39], s72 offen
  v_and_b32_dpp v24, v35, v16 row_newbcast:13 row_mask:0xf bank_mask:0xf
  v_and_b32_dpp v25, v35, v17 row_newbcast:13 row_mask:0xf bank_mask:0xf
  v_and_b32_dpp v26, v35, v18 row_newbcast:13 row_mask:0xf bank_mask:0xf
  v_and_b32_dpp v27, v35, v19 row_newbcast:13 row_mask:0xf bank_mask:0xf
  s_waitcnt vmcnt(20)
  v_mfma_f32_16x16x32_bf16 v[28:31], v[20:23], v[112:115], v[28:31]
  s_mov_b32 s72, 229376
  buffer_load_dwordx4 a[128:131], v9, s[36:39], s72 offen
  v_and_b32_dpp v20, v35, v16 row_newbcast:14 row_mask:0xf bank_mask:0xf
  v_and_b32_dpp v21, v35, v17 row_newbcast:14 row_mask:0xf bank_mask:0xf
  v_and_b32_dpp v22, v35, v18 row_newbcast:14 row_mask:0xf bank_mask:0xf
  v_and_b32_dpp v23, v35, v19 row_newbcast:14 row_mask:0xf bank_mask:0xf
  s_waitcnt vmcnt(20)
  v_mfma_f32_16x16x32_bf16 v[28:31], v[24:27], v[116:119], v[28:31]
  s_mov_b32 s72, 286720
  buffer_load_dwordx4 a[132:135], v9, s[36:39], s72 offen
  v_and_b32_dpp v24, v35, v16 row_newbcast:15 row_mask:0xf bank_mask:0xf
  v_and_b32_dpp v25, v35, v17 row_newbcast:15 row_mask:0xf bank_mask:0xf
  v_and_b32_dpp v26, v35, v18 row_newbcast:15 row_mask:0xf bank_mask:0xf
  v_and_b32_dpp v27, v35, v19 row_newbcast:15 row_mask:0xf bank_mask:0xf
  s_waitcnt vmcnt(20)
  v_mfma_f32_16x16x32_bf16 v[28:31], v[20:23], v[120:123], v[28:31]
  s_mov_b32 s72, 344064
  buffer_load_dwordx4 a[136:139], v9, s[36:39], s72 offen
  s_nop 1
  s_waitcnt vmcnt(20)
  v_mfma_f32_16x16x32_bf16 v[28:31], v[24:27], v[124:127], v[28:31]
  s_mov_b32 s72, 401408
  buffer_load_dwordx4 a[140:143], v9, s[36:39], s72 offen
  s_add_u32 s63, s63, 1
L_tail:
  s_mov_b32 s34, 1
  s_cmp_lg_u32 s60, 0
  s_cbranch_scc1 L_comb1
L_comb:
  s_lshl_b32 s72, s52, 3
  s_add_u32 s72, s72, s60
  v_mov_b32 v35, s72
  v_add_u32 v34, s60, v49
  v_mov_b32 v32, v7
  v_mov_b32 v33, v8
  ds_write_b128 v34, v[28:31] offset:10240
  ds_write_b64 v35, v[32:33] offset:12288
  v_and_b32 v36, 3, v0
  v_lshl_add_u32 v36, v36, 3, s60
  v_and_b32 v37, 0x1ff, v3
  v_add_u32 v37, s60, v37
  s_waitcnt lgkmcnt(0)
  s_barrier
  s_cmp_lg_u32 s52, 0
  s_cbranch_scc1 L_comb_done
  ds_read_b64 v[32:33], v36 offset:12288
  ds_read_b128 v[128:131], v37 offset:10240
  ds_read_b128 v[132:135], v37 offset:10752
  ds_read_b128 v[136:139], v37 offset:11264
  ds_read_b128 v[140:143], v37 offset:11776
  s_waitcnt lgkmcnt(4)
  v_max_f32_dpp v34, v32, v32 quad_perm:[2,3,0,1] row_mask:0xf bank_mask:0xf
  s_nop 1
  v_max_f32_dpp v34, v34, v34 quad_perm:[1,0,3,2] row_mask:0xf bank_mask:0xf
  v_sub_f32 v36, v32, v34
  v_mul_f32 v36, 0x3fb8aa3b, v36
  v_exp_f32 v36, v36
  s_nop 0
  v_mul_f32 v35, v36, v33
  s_waitcnt lgkmcnt(0)
  v_mul_f32_dpp v40, v36, v128 quad_perm:[0,0,0,0] row_mask:0xf bank_mask:0xf
  v_mul_f32_dpp v41, v36, v129 quad_perm:[0,0,0,0] row_mask:0xf bank_mask:0xf
  v_mul_f32_dpp v42, v36, v130 quad_perm:[0,0,0,0] row_mask:0xf bank_mask:0xf
  v_mul_f32_dpp v43, v36, v131 quad_perm:[0,0,0,0] row_mask:0xf bank_mask:0xf
  v_add_f32_dpp v35, v35, v35 quad_perm:[2,3,0,1] row_mask:0xf bank_mask:0xf
  v_fmac_f32_dpp v40, v36, v132 quad_perm:[1,1,1,1] row_mask:0xf bank_mask:0xf
  v_fmac_f32_dpp v41, v36, v133 quad_perm:[1,1,1,1] row_mask:0xf bank_mask:0xf
  v_fmac_f32_dpp v42, v36, v134 quad_perm:[1,1,1,1] row_mask:0xf bank_mask:0xf
  v_fmac_f32_dpp v43, v36, v135 quad_perm:[1,1,1,1] row_mask:0xf bank_mask:0xf
  v_fmac_f32_dpp v40, v36, v136 quad_perm:[2,2,2,2] row_mask:0xf bank_mask:0xf
  v_fmac_f32_dpp v41, v36, v137 quad_perm:[2,2,2,2] row_mask:0xf bank_mask:0xf
  v_fmac_f32_dpp v42, v36, v138 quad_perm:[2,2,2,2] row_mask:0xf bank_mask:0xf
  v_fmac_f32_dpp v43, v36, v139 quad_perm:[2,2,2,2] row_mask:0xf bank_mask:0xf
  v_fmac_f32_dpp v40, v36, v140 quad_perm:[3,3,3,3] row_mask:0xf bank_mask:0xf
  v_fmac_f32_dpp v41, v36, v141 quad_perm:[3,3,3,3] row_mask:0xf bank_mask:0xf
  v_fmac_f32_dpp v42, v36, v142 quad_perm:[3,3,3,3] row_mask:0xf bank_mask:0xf
  v_fmac_f32_dpp v43, v36, v143 quad_perm:[3,3,3,3] row_mask:0xf bank_mask:0xf
  v_add_f32_dpp v41, v35, v35 quad_perm:[1,0,3,2] row_mask:0xc bank_mask:0xf
  v_mov_b32_dpp v40, v34 quad_perm:[0,1,2,3] row_mask:0xc bank_mask:0xf
  v_min_u32 v40, -2, v40
  v_min_u32 v41, -2, v41
  v_min_u32 v42, -2, v42
  v_min_u32 v43, -2, v43
  buffer_store_dwordx4 v[40:43], v61, s[40:43], s58 offen sc1
L_comb_done:
  s_movk_i32 s60, 2560
  s_add_u32 s72, s2, 256
  s_lshl_b32 s58, s72, 10
  v_mov_b32 v9, 0
  ds_read_b64 v[14:15], v9 offset:12352
  s_waitcnt lgkmcnt(0)
  v_mov_b32 v7, v14
  v_mov_b32 v59, v15
  v_mov_b32 v28, 0
  v_mov_b32 v29, 0
  v_mov_b32 v30, 0
  v_mov_b32 v31, 0
  v_and_b32 v61, 0x1ff, v49
  v_lshrrev_b32 v8, 1, v1
  v_lshl_add_u32 v61, v8, 23, v61
  s_cmp_eq_u32 s34, 0
  s_cbranch_scc1 L_vloop
L_comb1:
  s_nop 5
  ds_write_b128 v49, v[28:31] offset:12800
  s_waitcnt lgkmcnt(0)
  s_barrier
  s_cmp_lg_u32 s52, 0
  s_cbranch_scc1 L_gather
  ds_read_b128 v[132:135], v49 offset:13312
  ds_read_b128 v[136:139], v49 offset:13824
  ds_read_b128 v[140:143], v49 offset:14336
  s_waitcnt lgkmcnt(2)
  v_add_f32 v28, v28, v132
  v_add_f32 v29, v29, v133
  v_add_f32 v30, v30, v134
  v_add_f32 v31, v31, v135
  s_waitcnt lgkmcnt(1)
  v_add_f32 v28, v28, v136
  v_add_f32 v29, v29, v137
  v_add_f32 v30, v30, v138
  v_add_f32 v31, v31, v139
  s_waitcnt lgkmcnt(0)
  v_add_f32 v28, v28, v140
  v_add_f32 v29, v29, v141
  v_add_f32 v30, v30, v142
  v_add_f32 v31, v31, v143
  v_min_u32 v128, -2, v28
  v_min_u32 v129, -2, v29
  v_min_u32 v130, -2, v30
  v_min_u32 v131, -2, v31
  buffer_store_dwordx4 v[128:131], v61, s[40:43], s58 offen sc1
L_gather:
  s_cmp_ge_u32 s76, 56
  s_cbranch_scc1 L_gather2
  v_lshl_add_u32 v10, v1, 10, v48
  s_lshl_b32 s73, s76, 15
  s_lshl_b32 s74, s52, 8
  s_add_u32 s73, s73, s74
  v_add_u32 v10, s73, v10
  s_mov_b32 s36, s20
  s_mov_b32 s37, s21
  s_mov_b32 s72, 0
  buffer_load_dwordx4 a[0:3], v10, s[36:39], s72 offen nt
  s_mov_b32 s72, 4096
  buffer_load_dwordx4 a[4:7], v10, s[36:39], s72 offen nt
  s_mov_b32 s72, 8192
  buffer_load_dwordx4 a[8:11], v10, s[36:39], s72 offen nt
  s_mov_b32 s72, 12288
  buffer_load_dwordx4 a[12:15], v10, s[36:39], s72 offen nt
  s_mov_b32 s72, 16384
  buffer_load_dwordx4 a[16:19], v10, s[36:39], s72 offen nt
  s_mov_b32 s72, 20480
  buffer_load_dwordx4 a[20:23], v10, s[36:39], s72 offen nt
  s_mov_b32 s72, 24576
  buffer_load_dwordx4 a[24:27], v10, s[36:39], s72 offen nt
  s_mov_b32 s72, 28672
  buffer_load_dwordx4 a[28:31], v10, s[36:39], s72 offen nt
  s_lshl_b32 s72, s52, 14
  v_add_u32 v9, s72, v3
  s_waitcnt vmcnt(8)
  ds_write_b128 v9, a[80:83] offset:23808
  ds_write_b128 v9, a[84:87] offset:24832
  ds_write_b128 v9, a[88:91] offset:25856
  ds_write_b128 v9, a[92:95] offset:26880
  ds_write_b128 v9, a[96:99] offset:27904
  ds_write_b128 v9, a[100:103] offset:28928
  ds_write_b128 v9, a[104:107] offset:29952
  ds_write_b128 v9, a[108:111] offset:30976
  ds_write_b128 v9, a[112:115] offset:32000
  ds_write_b128 v9, a[116:119] offset:33024
  ds_write_b128 v9, a[120:123] offset:34048
  ds_write_b128 v9, a[124:127] offset:35072
  ds_write_b128 v9, a[128:131] offset:36096
  ds_write_b128 v9, a[132:135] offset:37120
  ds_write_b128 v9, a[136:139] offset:38144
  ds_write_b128 v9, a[140:143] offset:39168
  v_lshrrev_b32 v9, 2, v2
  v_lshl_add_u32 v9, v1, 3, v9
  v_lshlrev_b32 v9, 6, v9
  v_and_b32 v10, 1, v2
  v_lshl_add_u32 v9, v10, 3, v9
  v_bfe_u32 v50, v2, 1, 1
  v_lshl_add_u32 v9, v50, 13, v9
  v_add_u32 v9, s72, v9
  v_lshlrev_b32 v10, 10, v10
  v_lshl_add_u32 v10, v1, 4, v10
  s_lshl_b32 s72, s52, 8
  v_add_u32 v10, s72, v10
  s_waitcnt lgkmcnt(0)
  ds_read_b128 v[32:35], v10 offset:0
  ds_read_b128 v[36:39], v10 offset:64
  ds_read_b128 v[40:43], v10 offset:128
  ds_read_b128 v[44:47], v10 offset:192
  ds_read_b64_tr_b16 v[64:65], v9 offset:23808
  ds_read_b64_tr_b16 v[66:67], v9 offset:24064
  ds_read_b64_tr_b16 v[68:69], v9 offset:25856
  ds_read_b64_tr_b16 v[70:71], v9 offset:26112
  ds_read_b64_tr_b16 v[72:73], v9 offset:27904
  ds_read_b64_tr_b16 v[74:75], v9 offset:28160
  ds_read_b64_tr_b16 v[76:77], v9 offset:29952
  ds_read_b64_tr_b16 v[78:79], v9 offset:30208
  s_waitcnt lgkmcnt(0)
  v_mfma_f32_16x16x32_bf16 v[160:163], v[32:35], v[64:67], 0
  v_mfma_f32_16x16x32_bf16 v[160:163], v[36:39], v[68:71], v[160:163]
  v_mfma_f32_16x16x32_bf16 v[160:163], v[40:43], v[72:75], v[160:163]
  v_mfma_f32_16x16x32_bf16 v[160:163], v[44:47], v[76:79], v[160:163]
  ds_read_b64_tr_b16 v[80:81], v9 offset:23824
  ds_read_b64_tr_b16 v[82:83], v9 offset:24080
  ds_read_b64_tr_b16 v[84:85], v9 offset:25872
  ds_read_b64_tr_b16 v[86:87], v9 offset:26128
  ds_read_b64_tr_b16 v[88:89], v9 offset:27920
  ds_read_b64_tr_b16 v[90:91], v9 offset:28176
  ds_read_b64_tr_b16 v[92:93], v9 offset:29968
  ds_read_b64_tr_b16 v[94:95], v9 offset:30224
  s_waitcnt lgkmcnt(0)
  v_mfma_f32_16x16x32_bf16 v[164:167], v[32:35], v[80:83], 0
  v_mfma_f32_16x16x32_bf16 v[164:167], v[36:39], v[84:87], v[164:167]
  v_mfma_f32_16x16x32_bf16 v[164:167], v[40:43], v[88:91], v[164:167]
  v_mfma_f32_16x16x32_bf16 v[164:167], v[44:47], v[92:95], v[164:167]
  ds_read_b64_tr_b16 v[96:97], v9 offset:23840
  ds_read_b64_tr_b16 v[98:99], v9 offset:24096
  ds_read_b64_tr_b16 v[100:101], v9 offset:25888
  ds_read_b64_tr_b16 v[102:103], v9 offset:26144
  ds_read_b64_tr_b16 v[104:105], v9 offset:27936
  ds_read_b64_tr_b16 v[106:107], v9 offset:28192
  ds_read_b64_tr_b16 v[108:109], v9 offset:29984
  ds_read_b64_tr_b16 v[110:111], v9 offset:30240
  s_waitcnt lgkmcnt(0)
  v_mfma_f32_16x16x32_bf16 v[168:171], v[32:35], v[96:99], 0
  v_mfma_f32_16x16x32_bf16 v[168:171], v[36:39], v[100:103], v[168:171]
  v_mfma_f32_16x16x32_bf16 v[168:171], v[40:43], v[104:107], v[168:171]
  v_mfma_f32_16x16x32_bf16 v[168:171], v[44:47], v[108:111], v[168:171]
  ds_read_b64_tr_b16 v[112:113], v9 offset:23856
  ds_read_b64_tr_b16 v[114:115], v9 offset:24112
  ds_read_b64_tr_b16 v[116:117], v9 offset:25904
  ds_read_b64_tr_b16 v[118:119], v9 offset:26160
  ds_read_b64_tr_b16 v[120:121], v9 offset:27952
  ds_read_b64_tr_b16 v[122:123], v9 offset:28208
  ds_read_b64_tr_b16 v[124:125], v9 offset:30000
  ds_read_b64_tr_b16 v[126:127], v9 offset:30256
  s_waitcnt lgkmcnt(0)
  v_mfma_f32_16x16x32_bf16 v[172:175], v[32:35], v[112:115], 0
  v_mfma_f32_16x16x32_bf16 v[172:175], v[36:39], v[116:119], v[172:175]
  v_mfma_f32_16x16x32_bf16 v[172:175], v[40:43], v[120:123], v[172:175]
  v_mfma_f32_16x16x32_bf16 v[172:175], v[44:47], v[124:127], v[172:175]
  s_lshl_b32 s72, s52, 9
  v_lshl_add_u32 v9, v2, 2, s72
  s_nop 7
  ds_write_b32 v9, v160 offset:2048
  ds_write_b32 v9, v161 offset:2112
  ds_write_b32 v9, v164 offset:2176
  ds_write_b32 v9, v165 offset:2240
  ds_write_b32 v9, v168 offset:2304
  ds_write_b32 v9, v169 offset:2368
  ds_write_b32 v9, v172 offset:2432
  ds_write_b32 v9, v173 offset:2496
  s_waitcnt lgkmcnt(0)
  s_barrier
  ds_read2st64_b32 v[32:33], v55 offset0:8 offset1:9
  ds_read2st64_b32 v[34:35], v55 offset0:10 offset1:11
  ds_read2st64_b32 v[36:37], v55 offset0:12 offset1:13
  ds_read2st64_b32 v[38:39], v55 offset0:14 offset1:15
  v_lshrrev_b32 v9, 3, v2
  v_lshlrev_b32 v9, 6, v9
  v_lshl_add_u32 v9, v1, 2, v9
  s_waitcnt lgkmcnt(0)
  v_add_f32 v32, v32, v34
  v_add_f32 v33, v33, v35
  v_add_f32 v32, v32, v36
  v_add_f32 v33, v33, v37
  v_add_f32 v32, v32, v38
  v_add_f32 v33, v33, v39
  v_cvt_pk_bf16_f32 v32, v32, v32
  v_lshlrev_b32 v32, 16, v32
  v_mul_f32 v34, 0xbfb8aa3b, v32
  v_exp_f32 v34, v34
  s_nop 0
  v_add_f32 v34, 1.0, v34
  v_rcp_f32 v34, v34
  s_nop 0
  v_mul_f32 v34, v32, v34
  v_cvt_pk_bf16_f32 v34, v34, v34
  v_lshlrev_b32 v34, 16, v34
  v_mul_f32_dpp v34, v32, v34 row_ror:8 row_mask:0xf bank_mask:0xf
  v_cvt_pk_bf16_f32 v34, v34, v34
  v_cvt_pk_bf16_f32 v33, v33, v33
  v_lshlrev_b32 v33, 16, v33
  v_mul_f32 v35, 0xbfb8aa3b, v33
  v_exp_f32 v35, v35
  s_nop 0
  v_add_f32 v35, 1.0, v35
  v_rcp_f32 v35, v35
  s_nop 0
  v_mul_f32 v35, v33, v35
  v_cvt_pk_bf16_f32 v35, v35, v35
  v_lshlrev_b32 v35, 16, v35
  v_mul_f32_dpp v35, v33, v35 row_ror:8 row_mask:0xf bank_mask:0xf
  v_cvt_pk_bf16_f32 v35, v35, v35
  ds_bpermute_b32 v36, v9, v34 offset:0
  ds_bpermute_b32 v37, v9, v34 offset:16
  ds_bpermute_b32 v38, v9, v34 offset:128
  ds_bpermute_b32 v39, v9, v34 offset:144
  ds_bpermute_b32 v40, v9, v35 offset:0
  ds_bpermute_b32 v41, v9, v35 offset:16
  ds_bpermute_b32 v42, v9, v35 offset:128
  ds_bpermute_b32 v43, v9, v35 offset:144
  s_waitcnt lgkmcnt(0)
  s_waitcnt vmcnt(0)
  v_and_b32 v20, v36, v16
  v_and_b32 v21, v36, v17
  v_and_b32 v22, v36, v18
  v_and_b32 v23, v36, v19
  v_and_b32 v24, v37, v16
  v_and_b32 v25, v37, v17
  v_and_b32 v26, v37, v18
  v_and_b32 v27, v37, v19
  v_mfma_f32_16x16x32_bf16 v[160:163], v[20:23], a[0:3], 0
  v_and_b32 v20, v38, v16
  v_and_b32 v21, v38, v17
  v_and_b32 v22, v38, v18
  v_and_b32 v23, v38, v19
  v_mfma_f32_16x16x32_bf16 v[160:163], v[24:27], a[4:7], v[160:163]
  v_and_b32 v24, v39, v16
  v_and_b32 v25, v39, v17
  v_and_b32 v26, v39, v18
  v_and_b32 v27, v39, v19
  v_mfma_f32_16x16x32_bf16 v[160:163], v[20:23], a[8:11], v[160:163]
  v_and_b32 v20, v40, v16
  v_and_b32 v21, v40, v17
  v_and_b32 v22, v40, v18
  v_and_b32 v23, v40, v19
  v_mfma_f32_16x16x32_bf16 v[160:163], v[24:27], a[12:15], v[160:163]
  v_and_b32 v24, v41, v16
  v_and_b32 v25, v41, v17
  v_and_b32 v26, v41, v18
  v_and_b32 v27, v41, v19
  v_mfma_f32_16x16x32_bf16 v[160:163], v[20:23], a[16:19], v[160:163]
  v_and_b32 v20, v42, v16
  v_and_b32 v21, v42, v17
  v_and_b32 v22, v42, v18
  v_and_b32 v23, v42, v19
  v_mfma_f32_16x16x32_bf16 v[160:163], v[24:27], a[20:23], v[160:163]
  v_and_b32 v24, v43, v16
  v_and_b32 v25, v43, v17
  v_and_b32 v26, v43, v18
  v_and_b32 v27, v43, v19
  v_mfma_f32_16x16x32_bf16 v[160:163], v[20:23], a[24:27], v[160:163]
  s_nop 1
  v_mfma_f32_16x16x32_bf16 v[160:163], v[24:27], a[28:31], v[160:163]
  s_lshl_b32 s72, s76, 7
  s_nop 6
  v_min_u32 v160, -2, v160
  v_min_u32 v161, -2, v161
  v_min_u32 v162, -2, v162
  v_min_u32 v163, -2, v163
  buffer_store_dwordx4 v[160:163], v54, s[40:43], s72 offen sc1
L_gather2:
  buffer_load_dwordx4 v[144:147], v56, s[40:43], 0 offen sc1
  s_waitcnt vmcnt(1)
  v_mov_b32 v150, 0
  s_mov_b32 exec_lo, 0x00ff00ff
  s_mov_b32 exec_hi, 0x00ff00ff
L_pm:
L_pm_chk:
  v_max3_u32 v32, v148, v149, v150
  v_cmp_eq_u32 vcc, -1, v32
  s_nop 4
  s_cbranch_vccz L_pm_done
  s_sub_u32 s83, s83, 1
  s_cbranch_scc1 L_pm_done
  s_mov_b64 exec, vcc
  buffer_load_dwordx2 v[148:149], v57, s[40:43], 0 offen offset:512 sc1
  s_waitcnt vmcnt(0)
  s_branch L_pm_chk
L_pm_done:
  s_mov_b64 exec, -1
  s_nop 1
  v_max_f32_dpp v150, v148, v148 quad_perm:[1,0,3,2] row_mask:0xf bank_mask:0xf
  s_nop 1
  v_max_f32_dpp v150, v150, v150 quad_perm:[2,3,0,1] row_mask:0xf bank_mask:0xf
  s_nop 1
  v_max_f32_dpp v150, v150, v150 row_half_mirror row_mask:0xf bank_mask:0xf
  v_sub_f32 v150, v148, v150
  v_mul_f32 v150, 0x3fb8aa3b, v150
  v_exp_f32 v150, v150
  s_nop 0
  v_mul_f32 v148, v150, v149
  s_nop 1
  v_add_f32_dpp v148, v148, v148 quad_perm:[1,0,3,2] row_mask:0xf bank_mask:0xf
  s_nop 1
  v_add_f32_dpp v148, v148, v148 quad_perm:[2,3,0,1] row_mask:0xf bank_mask:0xf
  s_nop 1
  v_add_f32_dpp v148, v148, v148 row_half_mirror row_mask:0xf bank_mask:0xf
  v_rcp_f32 v148, v148
  v_mov_b32 v149, 1.0
  v_mul_f32 v150, v150, v148
  s_nop 0
  v_mov_b32_dpp v150, v149 quad_perm:[0,1,2,3] row_mask:0xf bank_mask:0xc
L_pg:
  s_waitcnt vmcnt(0)
L_pg_chk:
  v_max3_u32 v32, v144, v145, v146
  v_max_u32 v32, v147, v32
  v_cmp_eq_u32 vcc, -1, v32
  s_nop 4
  s_cbranch_vccz L_pg_done
  s_sub_u32 s83, s83, 1
  s_cbranch_scc1 L_pg_done
  s_mov_b64 exec, vcc
  buffer_load_dwordx4 v[144:147], v56, s[40:43], 0 offen sc1
  s_waitcnt vmcnt(0)
  s_branch L_pg_chk
L_pg_done:
  s_mov_b64 exec, -1
  v_mul_f32 v144, v150, v144
  v_mul_f32 v145, v150, v145
  v_mul_f32 v146, v150, v146
  v_mul_f32 v147, v150, v147
  v_add_f32_dpp v144, v144, v144 quad_perm:[1,0,3,2] row_mask:0xf bank_mask:0xf
  v_add_f32_dpp v145, v145, v145 quad_perm:[1,0,3,2] row_mask:0xf bank_mask:0xf
  v_add_f32_dpp v146, v146, v146 quad_perm:[1,0,3,2] row_mask:0xf bank_mask:0xf
  v_add_f32_dpp v147, v147, v147 quad_perm:[1,0,3,2] row_mask:0xf bank_mask:0xf
  v_add_f32_dpp v144, v144, v144 quad_perm:[2,3,0,1] row_mask:0xf bank_mask:0xf
  v_add_f32_dpp v145, v145, v145 quad_perm:[2,3,0,1] row_mask:0xf bank_mask:0xf
  v_add_f32_dpp v146, v146, v146 quad_perm:[2,3,0,1] row_mask:0xf bank_mask:0xf
  v_add_f32_dpp v147, v147, v147 quad_perm:[2,3,0,1] row_mask:0xf bank_mask:0xf
  v_add_f32_dpp v144, v144, v144 row_half_mirror row_mask:0xf bank_mask:0xf
  v_add_f32_dpp v145, v145, v145 row_half_mirror row_mask:0xf bank_mask:0xf
  v_add_f32_dpp v146, v146, v146 row_half_mirror row_mask:0xf bank_mask:0xf
  v_add_f32_dpp v147, v147, v147 row_half_mirror row_mask:0xf bank_mask:0xf
  v_cvt_pk_bf16_f32 v144, v144, v144
  v_cvt_pk_bf16_f32 v145, v145, v145
  v_cvt_pk_bf16_f32 v146, v146, v146
  v_cvt_pk_bf16_f32 v147, v147, v147
  v_and_b32 v20, v144, v16
  v_and_b32 v21, v144, v17
  v_and_b32 v22, v144, v18
  v_and_b32 v23, v144, v19
  v_and_b32 v24, v145, v16
  v_and_b32 v25, v145, v17
  v_and_b32 v26, v145, v18
  v_and_b32 v27, v145, v19
  v_mfma_f32_16x16x32_bf16 v[28:31], v[20:23], a[64:67], 0
  v_and_b32 v20, v146, v16
  v_and_b32 v21, v146, v17
  v_and_b32 v22, v146, v18
  v_and_b32 v23, v146, v19
  v_mfma_f32_16x16x32_bf16 v[28:31], v[24:27], a[68:71], v[28:31]
  v_and_b32 v24, v147, v16
  v_and_b32 v25, v147, v17
  v_and_b32 v26, v147, v18
  v_and_b32 v27, v147, v19
  v_mfma_f32_16x16x32_bf16 v[28:31], v[20:23], a[72:75], v[28:31]
  s_nop 1
  v_mfma_f32_16x16x32_bf16 v[28:31], v[24:27], a[76:79], v[28:31]
  s_lshl_b32 s72, s52, 10
  v_add_u32 v32, s72, v3
  s_nop 5
  ds_write_b128 v32, v[28:31] offset:4096
  s_waitcnt lgkmcnt(0)
  s_barrier
  s_cmp_lg_u32 s52, 0
  s_cbranch_scc1 L_ydone
  ds_read_b128 v[148:151], v3 offset:5120
  ds_read_b128 v[152:155], v3 offset:6144
  ds_read_b128 v[156:159], v3 offset:7168
  s_waitcnt lgkmcnt(2)
  v_add_f32 v28, v28, v148
  v_add_f32 v29, v29, v149
  v_add_f32 v30, v30, v150
  v_add_f32 v31, v31, v151
  s_waitcnt lgkmcnt(1)
  v_add_f32 v28, v28, v152
  v_add_f32 v29, v29, v153
  v_add_f32 v30, v30, v154
  v_add_f32 v31, v31, v155
  s_waitcnt lgkmcnt(0)
  v_add_f32 v28, v28, v156
  v_add_f32 v29, v29, v157
  v_add_f32 v30, v30, v158
  v_add_f32 v31, v31, v159
  v_min_u32 v28, -2, v28
  v_min_u32 v29, -2, v29
  v_min_u32 v30, -2, v30
  v_min_u32 v31, -2, v31
  buffer_store_dwordx4 v[28:31], v4, s[40:43], 0 offen sc1
L_ydone:
  s_cmp_eq_u32 s77, 0
  s_cbranch_scc1 L_fin
  s_mov_b32 s74, 1048576
  s_cmp_eq_u32 s52, 3
  s_cselect_b32 s73, 8388608, s74
  buffer_load_dwordx4 v[200:203], v58, s[40:43], s74 offen sc1
  buffer_load_dwordx4 v[204:207], v58, s[40:43], s73 offen offset:1024 sc1
  buffer_load_dwordx4 v[192:195], v58, s[40:43], 0 offen offset:0 sc1
  buffer_load_dwordx4 v[196:199], v58, s[40:43], 0 offen offset:1024 sc1
  v_lshlrev_b32 v11, 16, v11
  v_bfe_u32 v9, v0, 3, 1
  v_lshl_add_u32 v53, v9, 20, v53
  s_waitcnt vmcnt(2)
L_pf:
L_pf_chk:
  v_max3_u32 v32, v200, v201, v202
  v_max3_u32 v32, v203, v204, v32
  v_max3_u32 v32, v205, v206, v32
  v_max_u32 v32, v207, v32
  v_cmp_eq_u32 vcc, -1, v32
  s_nop 4
  s_cbranch_vccz L_pf_done
  s_sub_u32 s83, s83, 1
  s_cbranch_scc1 L_pf_done
  s_mov_b64 exec, vcc
  buffer_load_dwordx4 v[200:203], v58, s[40:43], s74 offen sc1
  buffer_load_dwordx4 v[204:207], v58, s[40:43], s73 offen offset:1024 sc1
  s_waitcnt vmcnt(0)
  s_branch L_pf_chk
L_pf_done:
  s_mov_b64 exec, -1
  v_add_f32 v200, v200, v204
  v_add_f32 v201, v201, v205
  v_add_f32 v202, v202, v206
  v_add_f32 v203, v203, v207
  s_nop 1
  v_add_f32_dpp v200, v200, v200 row_ror:8 row_mask:0xf bank_mask:0xf
  v_add_f32_dpp v201, v201, v201 row_ror:8 row_mask:0xf bank_mask:0xf
  v_add_f32_dpp v202, v202, v202 row_ror:8 row_mask:0xf bank_mask:0xf
  v_add_f32_dpp v203, v203, v203 row_ror:8 row_mask:0xf bank_mask:0xf
  s_nop 1
  v_permlane16_swap_b32 v200, v201
  v_permlane16_swap_b32 v202, v203
  s_nop 1
  v_add_f32 v200, v200, v201
  v_add_f32 v202, v202, v203
  s_nop 1
  v_permlane32_swap_b32 v200, v202
  s_nop 1
  v_add_f32 v200, v200, v202
  ds_write_b32 v13, v200 offset:8192
L_py:
  s_waitcnt vmcnt(0)
L_py_chk:
  v_max3_u32 v32, v192, v193, v194
  v_max3_u32 v32, v195, v196, v32
  v_max3_u32 v32, v197, v198, v32
  v_max_u32 v32, v199, v32
  v_cmp_eq_u32 vcc, -1, v32
  s_nop 4
  s_cbranch_vccz L_py_done
  s_sub_u32 s83, s83, 1
  s_cbranch_scc1 L_py_done
  s_mov_b64 exec, vcc
  buffer_load_dwordx4 v[192:195], v58, s[40:43], 0 offen offset:0 sc1
  buffer_load_dwordx4 v[196:199], v58, s[40:43], 0 offen offset:1024 sc1
  s_waitcnt vmcnt(0)
  s_branch L_py_chk
L_py_done:
  s_mov_b64 exec, -1
  v_add_f32 v192, v192, v196
  v_add_f32 v193, v193, v197
  v_add_f32 v194, v194, v198
  v_add_f32 v195, v195, v199
  s_nop 1
  v_add_f32_dpp v192, v192, v192 row_ror:8 row_mask:0xf bank_mask:0xf
  v_add_f32_dpp v193, v193, v193 row_ror:8 row_mask:0xf bank_mask:0xf
  v_add_f32_dpp v194, v194, v194 row_ror:8 row_mask:0xf bank_mask:0xf
  v_add_f32_dpp v195, v195, v195 row_ror:8 row_mask:0xf bank_mask:0xf
  s_nop 1
  v_permlane16_swap_b32 v192, v193
  v_permlane16_swap_b32 v194, v195
  s_nop 1
  v_add_f32 v192, v192, v193
  v_add_f32 v194, v194, v195
  s_nop 1
  v_permlane32_swap_b32 v192, v194
  s_nop 1
  v_add_f32 v192, v192, v194
  ds_write_b32 v13, v192 offset:9216
  s_waitcnt lgkmcnt(0)
  s_barrier
  s_cmp_lg_u32 s52, 0
  s_cbranch_scc1 L_fin
  ds_read_b32 v208, v13 offset:8192
  ds_read_b32 v209, v13 offset:8448
  ds_read_b32 v210, v13 offset:8704
  ds_read_b32 v211, v13 offset:8960
  ds_read_b32 v213, v13 offset:9472
  ds_read_b32 v214, v13 offset:9728
  ds_read_b32 v215, v13 offset:9984
  s_waitcnt lgkmcnt(3)
  v_add_f32 v208, v208, v209
  v_add_f32 v210, v210, v211
  v_add_f32 v208, v208, v210
  v_cvt_pk_bf16_f32 v208, v208, v208
  v_lshlrev_b32 v208, 16, v208
  v_mul_f32 v209, 0xbfb8aa3b, v208
  v_exp_f32 v209, v209
  s_waitcnt lgkmcnt(0)
  v_add_f32 v192, v192, v213
  v_add_f32 v209, 1.0, v209
  v_rcp_f32 v209, v209
  v_add_f32 v214, v214, v215
  v_add_f32 v192, v192, v214
  v_mul_f32 v209, v208, v209
  v_cvt_pk_bf16_f32 v192, v192, v209
  v_and_b32 v209, 0xffff0000, v192
  v_lshlrev_b32 v192, 16, v192
  v_mul_f32 v192, v192, v209
  v_cvt_pk_bf16_f32 v192, v192, v192
  v_lshlrev_b32 v192, 16, v192
  v_add_f32 v192, v192, v11
  v_cvt_pk_bf16_f32 v192, v192, v192
  buffer_store_short v192, v53, s[48:51], 0 offen
L_fin:
L_end:
  s_endpgm
.section .rodata,"a"
.p2align 6
.amdhsa_kernel recurrent_scan__mha_block_cached__swiglu_ffn__decode_kernel
  .amdhsa_next_free_vgpr 448
  .amdhsa_next_free_sgpr 102
  .amdhsa_accum_offset 256
  .amdhsa_group_segment_fixed_size 0
  .amdhsa_kernarg_size 96
  .amdhsa_user_sgpr_count 2
  .amdhsa_user_sgpr_kernarg_segment_ptr 1
  .amdhsa_system_sgpr_workgroup_id_x 1
  .amdhsa_float_denorm_mode_32 3
.end_amdhsa_kernel
```
